```python
import torch

def _softmax(x, axis=-1):
    return torch.softmax(x, dim=axis)
def _gelu(x):
    return torch.nn.functional.gelu(x, approximate="tanh")
def _silu(x):
    return torch.nn.functional.silu(x)
def _sigmoid(x):
    return torch.sigmoid(x)
def _layernorm(x, axis=-1, eps=1e-5):
    m = x.mean(dim=axis, keepdim=True)
    v = x.var(dim=axis, keepdim=True, unbiased=False)
    return (x - m) / torch.sqrt(v + eps)
def _scatter_add(tgt, idx, src, axis=0):
    return tgt.clone().index_add_(axis, idx, src)
def _segment_sum(src, seg, n):
    out = torch.zeros((n,) + src.shape[1:], dtype=src.dtype)
    return out.index_add_(0, seg, src)
def _pad(x, pw):
    flat = tuple(v for pair in reversed(pw) for v in pair)
    return torch.nn.functional.pad(x, flat)

kernel_name = 'gated_mix__mha_block__softmax_full_mha__prompt'

def setup_inputs():

    _w = (lambda a: (lambda t: t.to(torch.bfloat16) if t.is_floating_point() else t)(torch.as_tensor(a)))
    def _A_setup():
        B, S, D, H = 1, 2048, 1024, 32
        return {
            "x": _w((lambda *s: torch.randn(*s, dtype=torch.bfloat16) * 0.05)(B, S, D)),
            "wqkv": _w((lambda *s: torch.randn(*s, dtype=torch.bfloat16) * 0.8)(D, 3 * D)),
            "wo": _w((lambda *s: torch.randn(*s, dtype=torch.bfloat16) * 0.05)(D, D)),
        }
    _A_in = _A_setup()

    def _B_setup():
        B, S, D = 1, 2048, 1024
        return {
            "x": _w((lambda *s: torch.randn(*s, dtype=torch.bfloat16) * 0.05)(B, S, D)),
            "wqkv": _w((lambda *s: torch.randn(*s, dtype=torch.bfloat16) * 0.8)(D, 3 * D)),
            "wo": _w((lambda *s: torch.randn(*s, dtype=torch.bfloat16) * 0.05)(D, D)),
        }
    _B_in = _B_setup()

    return {
        "A_x": _A_in["x"],
        "A_wqkv": _A_in["wqkv"],
        "A_wo": _A_in["wo"],
        "B_x": _B_in["x"],
        "B_wqkv": _B_in["wqkv"],
        "B_wo": _B_in["wo"],
        "gate_w": _w((lambda *s: torch.randn(*s, dtype=torch.bfloat16) * 0.05)(1024) * 16.0),
    }

def reference(A_x, A_wqkv, A_wo, B_x, B_wqkv, B_wo, gate_w):
    def _A_ref(x, wqkv, wo):
        B, S, D = x.shape
        H = 32
        Dh = D // H
        qkv = (lambda x, *d: x.permute(*d))((x @ wqkv).reshape(B, S, 3, H, Dh), 2, 0, 3, 1, 4)
        q, k, v = qkv[0], qkv[1], qkv[2]
        scores = torch.einsum("bhqd,bhkd->bhqk", q, k) * (Dh ** -0.5)
        p = _softmax(scores, axis=-1)
        o = torch.einsum("bhqk,bhkd->bhqd", p, v)
        return (lambda x, *d: x.permute(*d))(o, 0, 2, 1, 3).reshape(B, S, D) @ wo

    def _B_ref(x, wqkv, wo):
        B, S, D = x.shape
        H = 32; Dh = D // H
        qkv = (lambda x, *d: x.permute(*d))((x @ wqkv).reshape(B, S, 3, H, Dh), 2, 0, 3, 1, 4)
        q, k, v = qkv[0], qkv[1], qkv[2]
        scale = Dh ** -0.5
        scores = torch.einsum("bhqd,bhkd->bhqk", q, k) * scale
        p = _softmax(scores, axis=-1)
        o = torch.einsum("bhqk,bhkd->bhqd", p, v)
        return (lambda x, *d: x.permute(*d))(o, 0, 2, 1, 3).reshape(B, S, D) @ wo

    x = A_x
    g = _sigmoid((x * gate_w).sum(-1, keepdims=True))
    a = _A_ref(x, A_wqkv, A_wo)
    b = _B_ref(x, B_wqkv, B_wo)
    return g * a + (1 - g) * b
```

```asm
; @launch grid=(256,1,1) block=(512,1,1) lds=163840
.amdgcn_target "amdgcn-amd-amdhsa--gfx950"
.text
.globl gated_mix__mha_block__softmax_full_mha__prompt_kernel
.p2align 8
.type gated_mix__mha_block__softmax_full_mha__prompt_kernel,@function
gated_mix__mha_block__softmax_full_mha__prompt_kernel:
    s_cmp_ge_u32 s2, 256
    s_cbranch_scc1 gated_mix__mha_block__softmax_full_mha__prompt_kernel_end
    s_load_dwordx4 s[40:43], s[0:1], 0
    s_load_dwordx2 s[44:45], s[0:1], 16
    s_load_dwordx4 s[48:51], s[0:1], 32
    s_load_dwordx4 s[52:55], s[0:1], 48
    s_load_dwordx4 s[56:59], s[0:1], 64
    v_lshrrev_b32 v2, 6, v0
    v_and_b32 v1, 63, v0
    v_readfirstlane_b32 s20, v2
    s_and_b32 s23, s2, 31
    s_lshr_b32 s24, s2, 5
    s_lshr_b32 s25, s23, 4
    s_and_b32 s26, s23, 15
    s_and_b32 s21, s20, 3
    s_lshr_b32 s22, s20, 2
    s_lshl_b32 s27, s25, 5
    s_lshl_b32 s28, s26, 1
    s_add_u32 s27, s27, s28
    s_add_u32 s27, s27, s22
    v_lshlrev_b32 v5, 4, v1
    s_lshl_b32 s30, s20, 10
    s_lshl_b32 s34, s21, 13
    v_lshrrev_b32 v2, 3, v1
    s_lshl_b32 s28, s20, 3
    v_add_u32 v2, s28, v2
    v_lshrrev_b32 v3, 1, v2
    v_and_b32 v8, 7, v3
    v_and_b32 v4, 7, v1
    v_xor_b32 v8, v8, v4
    v_lshlrev_b32 v8, 4, v8
    v_lshl_add_u32 v10, v2, 11, v8
    v_and_b32 v3, 1, v3
    v_lshlrev_b32 v3, 2, v3
    v_xor_b32 v3, v3, v4
    s_and_b32 s28, s20, 1
    s_lshl_b32 s28, s28, 1
    v_xor_b32 v3, s28, v3
    v_lshlrev_b32 v3, 4, v3
    v_mul_u32_u24 v2, 6144, v2
    v_add_u32 v11, v2, v3
    s_lshl_b32 s31, s24, 19
    s_lshl_b32 s32, s26, 7
    s_waitcnt lgkmcnt(0)
    s_mov_b32 s4, s40
    s_mov_b32 s5, s41
    s_mov_b32 s6, 4194304
    s_mov_b32 s7, 0x20000
    s_cmp_eq_u32 s25, 0
    s_cselect_b32 s8, s42, s48
    s_cselect_b32 s9, s43, s49
    s_mov_b32 s10, 6291456
    s_mov_b32 s11, 0x20000
    s_mov_b32 s12, s58
    s_mov_b32 s13, s59
    s_mov_b32 s14, 34619392
    s_mov_b32 s15, 0x20000
    s_mov_b32 s36, s56
    s_mov_b32 s37, s57
    s_mov_b32 s38, 256
    s_mov_b32 s39, 0x20000
    s_lshl_b32 s28, s20, 8
    s_add_u32 s28, s28, s2
    s_cmp_lt_u32 s28, 64
    s_cbranch_scc0 gated_mix__mha_block__softmax_full_mha__prompt_kernel_nz
    v_mov_b32 v24, 0
    v_mov_b32 v25, 0
    v_mov_b32 v26, 0
    v_mov_b32 v27, 0
    s_lshl_b32 s28, s2, 8
    s_add_u32 s28, s28, 34603008
    v_add_u32 v28, s28, v5
    v_cmp_gt_u32 vcc, 8, v1
    s_and_saveexec_b64 s[16:17], vcc
    buffer_store_dwordx4 v[24:27], v28, s[12:15], 0 offen sc1
    s_mov_b64 exec, s[16:17]
gated_mix__mha_block__softmax_full_mha__prompt_kernel_nz:
    s_add_u32 m0, s30, 0
    s_add_u32 s28, s31, 0
    buffer_load_dwordx4 v10, s[4:7], s28 offen lds
    s_add_u32 m0, s30, 8192
    s_add_u32 s28, s31, 131072
    buffer_load_dwordx4 v10, s[4:7], s28 offen lds
    s_add_u32 m0, s30, 16384
    s_add_u32 s28, s31, 262144
    buffer_load_dwordx4 v10, s[4:7], s28 offen lds
    s_add_u32 m0, s30, 24576
    s_add_u32 s28, s31, 393216
    buffer_load_dwordx4 v10, s[4:7], s28 offen lds
    s_add_u32 m0, s30, 32768
    s_add_u32 s28, s32, 0
    buffer_load_dwordx4 v11, s[8:11], s28 offen lds
    s_add_u32 m0, s30, 40960
    s_add_u32 s28, s32, 2048
    buffer_load_dwordx4 v11, s[8:11], s28 offen lds
    s_add_u32 m0, s30, 49152
    s_add_u32 s28, s32, 4096
    buffer_load_dwordx4 v11, s[8:11], s28 offen lds
    s_add_u32 m0, s30, 57344
    s_add_u32 s28, s31, 128
    buffer_load_dwordx4 v10, s[4:7], s28 offen lds
    s_add_u32 m0, s30, 65536
    s_add_u32 s28, s31, 131200
    buffer_load_dwordx4 v10, s[4:7], s28 offen lds
    s_add_u32 m0, s30, 73728
    s_add_u32 s28, s31, 262272
    buffer_load_dwordx4 v10, s[4:7], s28 offen lds
    s_add_u32 m0, s30, 81920
    s_add_u32 s28, s31, 393344
    buffer_load_dwordx4 v10, s[4:7], s28 offen lds
    s_add_u32 m0, s30, 90112
    s_add_u32 s28, s32, 393216
    buffer_load_dwordx4 v11, s[8:11], s28 offen lds
    s_add_u32 m0, s30, 98304
    s_add_u32 s28, s32, 395264
    buffer_load_dwordx4 v11, s[8:11], s28 offen lds
    s_cmp_lt_u32 s2, 32
    s_cselect_b32 s28, 1, 0
    s_sub_u32 s29, s2, 32
    s_cmp_ge_u32 s29, 48
    s_cselect_b32 s92, s48, s42
    s_cselect_b32 s93, s49, s43
    s_cselect_b32 s3, 48, 0
    s_sub_u32 s29, s29, s3
    s_lshl_b32 s101, s29, 7
    s_mov_b32 s3, 393216
    s_mov_b32 s94, 6291456
    s_mov_b32 s95, 0x20000
    v_mul_u32_u24 v218, 6144, v1
    s_cmp_eq_u32 s28, 1
    s_cbranch_scc0 gated_mix__mha_block__softmax_full_mha__prompt_kernel_tx
    s_mov_b32 s92, s40
    s_mov_b32 s93, s41
    s_mov_b32 s94, 4194304
    s_lshl_b32 s101, s2, 17
    s_mov_b32 s3, 128
    v_lshlrev_b32 v218, 11, v1
gated_mix__mha_block__softmax_full_mha__prompt_kernel_tx:
    s_lshr_b32 s28, s2, 7
    s_lshl_b32 s28, s28, 3
    s_add_u32 s28, s28, 7
    s_cmp_eq_u32 s28, s20
    s_cselect_b32 s63, 1, 0
    s_cmp_eq_u32 s63, 1
    s_cbranch_scc0 gated_mix__mha_block__softmax_full_mha__prompt_kernel_tc1
    s_mul_i32 s28, s3, 2
    s_add_u32 s28, s28, s101
    buffer_load_dword v219, v218, s[92:95], s28 offen
gated_mix__mha_block__softmax_full_mha__prompt_kernel_tc1:
    s_cmp_eq_u32 s63, 1
    s_cbranch_scc0 gated_mix__mha_block__softmax_full_mha__prompt_kernel_tc2
    s_mul_i32 s28, s3, 3
    s_add_u32 s28, s28, s101
    buffer_load_dword v219, v218, s[92:95], s28 offen
gated_mix__mha_block__softmax_full_mha__prompt_kernel_tc2:
    s_mov_b32 s16, s52
    s_mov_b32 s17, s53
    s_mov_b32 s18, 2048
    s_mov_b32 s19, 0x20000
    s_lshl_b32 s28, s24, 5
    s_add_u32 s28, s28, s23
    s_lshl_b32 s28, s28, 3
    s_add_u32 s28, s28, s20
    s_lshl_b32 s35, s28, 2
    s_lshl_b32 s28, s28, 11
    v_lshlrev_b32 v3, 5, v1
    buffer_load_dwordx4 v[200:203], v3, s[4:7], s28 offen
    buffer_load_dwordx4 v[204:207], v3, s[4:7], s28 offen offset:16
    buffer_load_dwordx4 v[208:211], v3, s[16:19], 0 offen
    buffer_load_dwordx4 v[212:215], v3, s[16:19], 0 offen offset:16
    v_and_b32 v2, 15, v1
    v_lshrrev_b32 v3, 4, v1
    v_lshrrev_b32 v4, 1, v2
    v_xor_b32 v3, v3, v4
    v_lshlrev_b32 v3, 4, v3
    v_lshl_add_u32 v12, v2, 7, v3
    v_xor_b32 v13, 64, v12
    v_and_b32 v2, 15, v1
    v_lshrrev_b32 v3, 4, v1
    v_lshlrev_b32 v3, 3, v3
    v_lshrrev_b32 v4, 2, v2
    v_add_u32 v3, v3, v4
    v_lshlrev_b32 v14, 7, v3
    v_lshrrev_b32 v3, 3, v2
    v_xor_b32 v3, s22, v3
    v_lshl_add_u32 v14, v3, 6, v14
    v_bfe_u32 v3, v1, 4, 1
    v_lshl_add_u32 v14, v3, 5, v14
    v_and_b32 v3, 3, v2
    v_lshl_add_u32 v14, v3, 3, v14
    v_xor_b32 v15, 32, v14
    v_lshrrev_b32 v3, 4, v1
    v_lshlrev_b32 v249, 9, v3
    v_lshl_add_u32 v249, v2, 4, v249
    v_lshlrev_b32 v248, 9, v3
    v_lshrrev_b32 v3, 3, v2
    v_lshl_add_u32 v248, v3, 8, v248
    v_and_b32 v3, 7, v2
    v_lshl_add_u32 v248, v3, 4, v248
    v_mov_b32 v104, 0
    v_mov_b32 v105, 0
    v_mov_b32 v106, 0
    v_mov_b32 v107, 0
    v_mov_b32 v108, 0
    v_mov_b32 v109, 0
    v_mov_b32 v110, 0
    v_mov_b32 v111, 0
    v_mov_b32 v112, 0
    v_mov_b32 v113, 0
    v_mov_b32 v114, 0
    v_mov_b32 v115, 0
    v_mov_b32 v116, 0
    v_mov_b32 v117, 0
    v_mov_b32 v118, 0
    v_mov_b32 v119, 0
    v_mov_b32 v120, 0
    v_mov_b32 v121, 0
    v_mov_b32 v122, 0
    v_mov_b32 v123, 0
    v_mov_b32 v124, 0
    v_mov_b32 v125, 0
    v_mov_b32 v126, 0
    v_mov_b32 v127, 0
    v_mov_b32 v128, 0
    v_mov_b32 v129, 0
    v_mov_b32 v130, 0
    v_mov_b32 v131, 0
    v_mov_b32 v132, 0
    v_mov_b32 v133, 0
    v_mov_b32 v134, 0
    v_mov_b32 v135, 0
    v_mov_b32 v136, 0
    v_mov_b32 v137, 0
    v_mov_b32 v138, 0
    v_mov_b32 v139, 0
    v_mov_b32 v140, 0
    v_mov_b32 v141, 0
    v_mov_b32 v142, 0
    v_mov_b32 v143, 0
    v_mov_b32 v144, 0
    v_mov_b32 v145, 0
    v_mov_b32 v146, 0
    v_mov_b32 v147, 0
    v_mov_b32 v148, 0
    v_mov_b32 v149, 0
    v_mov_b32 v150, 0
    v_mov_b32 v151, 0
    v_mov_b32 v152, 0
    v_mov_b32 v153, 0
    v_mov_b32 v154, 0
    v_mov_b32 v155, 0
    v_mov_b32 v156, 0
    v_mov_b32 v157, 0
    v_mov_b32 v158, 0
    v_mov_b32 v159, 0
    v_mov_b32 v160, 0
    v_mov_b32 v161, 0
    v_mov_b32 v162, 0
    v_mov_b32 v163, 0
    v_mov_b32 v164, 0
    v_mov_b32 v165, 0
    v_mov_b32 v166, 0
    v_mov_b32 v167, 0
    v_mov_b32 v168, 0
    v_mov_b32 v169, 0
    v_mov_b32 v170, 0
    v_mov_b32 v171, 0
    v_mov_b32 v172, 0
    v_mov_b32 v173, 0
    v_mov_b32 v174, 0
    v_mov_b32 v175, 0
    v_mov_b32 v176, 0
    v_mov_b32 v177, 0
    v_mov_b32 v178, 0
    v_mov_b32 v179, 0
    v_mov_b32 v180, 0
    v_mov_b32 v181, 0
    v_mov_b32 v182, 0
    v_mov_b32 v183, 0
    v_mov_b32 v184, 0
    v_mov_b32 v185, 0
    v_mov_b32 v186, 0
    v_mov_b32 v187, 0
    v_mov_b32 v188, 0
    v_mov_b32 v189, 0
    v_mov_b32 v190, 0
    v_mov_b32 v191, 0
    v_mov_b32 v192, 0
    v_mov_b32 v193, 0
    v_mov_b32 v194, 0
    v_mov_b32 v195, 0
    v_mov_b32 v196, 0
    v_mov_b32 v197, 0
    v_mov_b32 v198, 0
    v_mov_b32 v199, 0
    s_and_b32 s28, s2, 7
    s_lshl_b32 s28, s28, 1
    s_lshr_b32 s29, s2, 3
    s_and_b32 s62, s29, 1
    s_add_u32 s62, s62, s28
    s_lshr_b32 s46, s29, 1
    s_and_b32 s28, s2, 7
    s_lshr_b32 s28, s28, 3
    s_lshl_b32 s28, s28, 4
    s_add_u32 s46, s46, s28
    s_lshr_b32 s47, s62, 1
    v_lshrrev_b32 v2, 3, v1
    s_lshl_b32 s28, s21, 4
    v_add_u32 v2, s28, v2
    v_bfe_u32 v3, v2, 1, 1
    v_lshlrev_b32 v3, 2, v3
    v_and_b32 v4, 7, v1
    v_xor_b32 v3, v3, v4
    v_lshlrev_b32 v3, 4, v3
    v_lshl_add_u32 v240, v2, 11, v3
    s_lshl_b32 s60, s46, 7
    s_lshl_b32 s61, s22, 13
    s_lshl_b32 s28, s21, 11
    s_add_u32 s61, s61, s28
    s_lshl_b32 s96, s27, 18
    s_lshl_b32 s28, s21, 11
    s_add_u32 s96, s96, s28
    s_add_u32 s96, s96, 8388608
    s_lshl_b32 s97, s22, 13
    v_add_u32 v251, s97, v5
    v_add_u32 v241, 65536, v251
    s_add_u32 s97, s97, s28
    s_add_u32 s97, s97, 65536
    s_add_u32 s98, s24, 1
    s_and_b32 s98, s98, 7
    s_lshl_b32 s98, s98, 15
    s_add_u32 s98, s98, s96
    s_add_u32 s99, s24, 2
    s_and_b32 s99, s99, 7
    s_lshl_b32 s99, s99, 15
    s_add_u32 s99, s99, s96
    s_lshl_b32 s28, s23, 8
    s_add_u32 s28, s28, 34603008
    s_lshl_b32 s29, s24, 4
    s_add_u32 s29, s29, s28
    v_mov_b32 v242, s29
    v_bfe_u32 v2, v1, 2, 1
    v_cmp_eq_u32 vcc, 0, v2
    v_mov_b32 v3, 0x3f803f80
    v_and_b32 v4, 1, v1
    v_cndmask_b32 v252, 0, v3, vcc
    v_mov_b32 v253, v252
    v_sub_u32 v254, v3, v252
    v_bfe_u32 v2, v1, 1, 1
    v_subrev_u32 v2, 1, v2
    v_and_b32 v252, v252, v2
    v_and_b32 v254, v254, v2
    v_mov_b32 v253, v252
    v_mov_b32 v255, v254
    v_cmp_eq_u32 vcc, 0, v4
    v_mov_b32 v3, 0x4444
    v_mov_b32 v4, 0xeeee
    v_cndmask_b32 v250, v4, v3, vcc
    s_lshl_b32 s28, s27, 6
    s_lshl_b32 s29, s24, 3
    s_add_u32 s28, s28, s29
    s_lshl_b32 s29, s21, 1
    s_add_u32 s28, s28, s29
    s_lshl_b32 s28, s28, 12
    s_add_u32 s100, s28, 8388608
    s_waitcnt vmcnt(10)
    s_barrier
    s_lshl_b32 s28, s20, 8
    s_add_u32 s28, s28, s2
    s_cmp_lt_u32 s28, 64
    s_cbranch_scc0 gated_mix__mha_block__softmax_full_mha__prompt_kernel_ni
    v_lshlrev_b32 v2, 6, v1
    v_mov_b32 v3, 1
    v_cmp_gt_u32 vcc, 4, v1
    s_and_saveexec_b64 s[16:17], vcc
    buffer_atomic_add v3, v2, s[36:39], 0 offen sc1
    s_mov_b64 exec, s[16:17]
gated_mix__mha_block__softmax_full_mha__prompt_kernel_ni:
    s_add_u32 s33, s34, 0
    s_cmp_ge_u32 s33, 163840
    s_cselect_b32 s29, 163840, 0
    s_sub_u32 s33, s33, s29
    v_add_u32 v16, s33, v12
    v_add_u32 v17, s33, v13
    v_add_u32 v18, 32768, v14
    v_add_u32 v19, 32768, v15
    v_add_u32 v20, 40960, v14
    v_add_u32 v21, 40960, v15
    v_add_u32 v22, 49152, v14
    v_add_u32 v23, 49152, v15
    ds_read_b128 v[24:27], v16 offset:0
    ds_read_b128 v[28:31], v16 offset:2048
    ds_read_b128 v[32:35], v16 offset:4096
    ds_read_b128 v[36:39], v16 offset:6144
    ds_read_b64_tr_b16 v[40:41], v18 offset:0
    ds_read_b64_tr_b16 v[42:43], v18 offset:512
    ds_read_b64_tr_b16 v[44:45], v19 offset:0
    ds_read_b64_tr_b16 v[46:47], v19 offset:512
    ds_read_b64_tr_b16 v[48:49], v20 offset:0
    ds_read_b64_tr_b16 v[50:51], v20 offset:512
    ds_read_b64_tr_b16 v[52:53], v21 offset:0
    ds_read_b64_tr_b16 v[54:55], v21 offset:512
    s_waitcnt lgkmcnt(8)
    ds_read_b64_tr_b16 v[56:57], v22 offset:0
    ds_read_b64_tr_b16 v[58:59], v22 offset:512
    ds_read_b64_tr_b16 v[60:61], v23 offset:0
    ds_read_b64_tr_b16 v[62:63], v23 offset:512
    s_add_u32 m0, s30, 106496
    s_add_u32 s28, s32, 397312
    buffer_load_dwordx4 v11, s[8:11], s28 offen lds
    s_add_u32 m0, s30, 114688
    s_add_u32 s28, s31, 256
    buffer_load_dwordx4 v10, s[4:7], s28 offen lds
    s_add_u32 m0, s30, 122880
    s_add_u32 s28, s31, 131328
    buffer_load_dwordx4 v10, s[4:7], s28 offen lds
    s_add_u32 m0, s30, 131072
    s_add_u32 s28, s31, 262400
    buffer_load_dwordx4 v10, s[4:7], s28 offen lds
    s_waitcnt lgkmcnt(0)
    v_mfma_f32_16x16x32_bf16 v[104:107], v[40:43], v[24:27], v[104:107]
    ds_read_b128 v[64:67], v17 offset:0
    v_mfma_f32_16x16x32_bf16 v[112:115], v[40:43], v[28:31], v[112:115]
    ds_read_b128 v[68:71], v17 offset:2048
    s_add_u32 m0, s30, 139264
    s_add_u32 s28, s31, 393472
    v_mfma_f32_16x16x32_bf16 v[120:123], v[40:43], v[32:35], v[120:123]
    ds_read_b128 v[72:75], v17 offset:4096
    v_mfma_f32_16x16x32_bf16 v[128:131], v[40:43], v[36:39], v[128:131]
    ds_read_b128 v[76:79], v17 offset:6144
    buffer_load_dwordx4 v10, s[4:7], s28 offen lds
    v_mfma_f32_16x16x32_bf16 v[108:111], v[44:47], v[24:27], v[108:111]
    ds_read_b64_tr_b16 v[80:81], v18 offset:4096
    v_mfma_f32_16x16x32_bf16 v[116:119], v[44:47], v[28:31], v[116:119]
    ds_read_b64_tr_b16 v[82:83], v18 offset:4608
    s_add_u32 m0, s30, 147456
    s_add_u32 s28, s32, 786432
    v_mfma_f32_16x16x32_bf16 v[124:127], v[44:47], v[32:35], v[124:127]
    ds_read_b64_tr_b16 v[84:85], v19 offset:4096
    v_mfma_f32_16x16x32_bf16 v[132:135], v[44:47], v[36:39], v[132:135]
    ds_read_b64_tr_b16 v[86:87], v19 offset:4608
    buffer_load_dwordx4 v11, s[8:11], s28 offen lds
    v_mfma_f32_16x16x32_bf16 v[136:139], v[48:51], v[24:27], v[136:139]
    ds_read_b64_tr_b16 v[88:89], v20 offset:4096
    v_mfma_f32_16x16x32_bf16 v[144:147], v[48:51], v[28:31], v[144:147]
    ds_read_b64_tr_b16 v[90:91], v20 offset:4608
    s_add_u32 m0, s30, 155648
    s_add_u32 s28, s32, 788480
    v_mfma_f32_16x16x32_bf16 v[152:155], v[48:51], v[32:35], v[152:155]
    ds_read_b64_tr_b16 v[92:93], v21 offset:4096
    v_mfma_f32_16x16x32_bf16 v[160:163], v[48:51], v[36:39], v[160:163]
    ds_read_b64_tr_b16 v[94:95], v21 offset:4608
    buffer_load_dwordx4 v11, s[8:11], s28 offen lds
    v_mfma_f32_16x16x32_bf16 v[140:143], v[52:55], v[24:27], v[140:143]
    s_waitcnt lgkmcnt(8)
    ds_read_b64_tr_b16 v[96:97], v22 offset:4096
    v_mfma_f32_16x16x32_bf16 v[148:151], v[52:55], v[28:31], v[148:151]
    ds_read_b64_tr_b16 v[98:99], v22 offset:4608
    v_mfma_f32_16x16x32_bf16 v[156:159], v[52:55], v[32:35], v[156:159]
    ds_read_b64_tr_b16 v[100:101], v23 offset:4096
    v_mfma_f32_16x16x32_bf16 v[164:167], v[52:55], v[36:39], v[164:167]
    ds_read_b64_tr_b16 v[102:103], v23 offset:4608
    v_mfma_f32_16x16x32_bf16 v[168:171], v[24:27], v[56:59], v[168:171]
    s_add_u32 s33, s34, 57344
    s_cmp_ge_u32 s33, 163840
    s_cselect_b32 s29, 163840, 0
    s_sub_u32 s33, s33, s29
    v_add_u32 v16, s33, v12
    v_mfma_f32_16x16x32_bf16 v[176:179], v[28:31], v[56:59], v[176:179]
    v_add_u32 v17, s33, v13
    v_mfma_f32_16x16x32_bf16 v[184:187], v[32:35], v[56:59], v[184:187]
    v_add_u32 v18, 90112, v14
    v_mfma_f32_16x16x32_bf16 v[192:195], v[36:39], v[56:59], v[192:195]
    v_add_u32 v19, 90112, v15
    v_mfma_f32_16x16x32_bf16 v[172:175], v[24:27], v[60:63], v[172:175]
    v_add_u32 v20, 98304, v14
    v_mfma_f32_16x16x32_bf16 v[180:183], v[28:31], v[60:63], v[180:183]
    v_add_u32 v21, 98304, v15
    v_mfma_f32_16x16x32_bf16 v[188:191], v[32:35], v[60:63], v[188:191]
    v_add_u32 v22, 106496, v14
    v_mfma_f32_16x16x32_bf16 v[196:199], v[36:39], v[60:63], v[196:199]
    v_add_u32 v23, 106496, v15
    s_cmp_eq_u32 s63, 1
    s_cbranch_scc0 gated_mix__mha_block__softmax_full_mha__prompt_kernel_tc3
    s_mul_i32 s28, s3, 4
    s_add_u32 s28, s28, s101
    buffer_load_dword v219, v218, s[92:95], s28 offen
gated_mix__mha_block__softmax_full_mha__prompt_kernel_tc3:
    s_waitcnt vmcnt(6) lgkmcnt(0)
    s_barrier
    v_mfma_f32_16x16x32_bf16 v[104:107], v[80:83], v[64:67], v[104:107]
    ds_read_b128 v[24:27], v16 offset:0
    v_mfma_f32_16x16x32_bf16 v[112:115], v[80:83], v[68:71], v[112:115]
    ds_read_b128 v[28:31], v16 offset:2048
    v_mfma_f32_16x16x32_bf16 v[120:123], v[80:83], v[72:75], v[120:123]
    ds_read_b128 v[32:35], v16 offset:4096
    v_mfma_f32_16x16x32_bf16 v[128:131], v[80:83], v[76:79], v[128:131]
    ds_read_b128 v[36:39], v16 offset:6144
    v_mfma_f32_16x16x32_bf16 v[108:111], v[84:87], v[64:67], v[108:111]
    ds_read_b64_tr_b16 v[40:41], v18 offset:0
    v_mfma_f32_16x16x32_bf16 v[116:119], v[84:87], v[68:71], v[116:119]
    ds_read_b64_tr_b16 v[42:43], v18 offset:512
    v_mfma_f32_16x16x32_bf16 v[124:127], v[84:87], v[72:75], v[124:127]
    ds_read_b64_tr_b16 v[44:45], v19 offset:0
    v_mfma_f32_16x16x32_bf16 v[132:135], v[84:87], v[76:79], v[132:135]
    ds_read_b64_tr_b16 v[46:47], v19 offset:512
    v_mfma_f32_16x16x32_bf16 v[136:139], v[88:91], v[64:67], v[136:139]
    ds_read_b64_tr_b16 v[48:49], v20 offset:0
    v_mfma_f32_16x16x32_bf16 v[144:147], v[88:91], v[68:71], v[144:147]
    ds_read_b64_tr_b16 v[50:51], v20 offset:512
    v_mfma_f32_16x16x32_bf16 v[152:155], v[88:91], v[72:75], v[152:155]
    ds_read_b64_tr_b16 v[52:53], v21 offset:0
    v_mfma_f32_16x16x32_bf16 v[160:163], v[88:91], v[76:79], v[160:163]
    ds_read_b64_tr_b16 v[54:55], v21 offset:512
    v_mfma_f32_16x16x32_bf16 v[140:143], v[92:95], v[64:67], v[140:143]
    s_waitcnt lgkmcnt(8)
    ds_read_b64_tr_b16 v[56:57], v22 offset:0
    v_mfma_f32_16x16x32_bf16 v[148:151], v[92:95], v[68:71], v[148:151]
    ds_read_b64_tr_b16 v[58:59], v22 offset:512
    v_mfma_f32_16x16x32_bf16 v[156:159], v[92:95], v[72:75], v[156:159]
    ds_read_b64_tr_b16 v[60:61], v23 offset:0
    v_mfma_f32_16x16x32_bf16 v[164:167], v[92:95], v[76:79], v[164:167]
    ds_read_b64_tr_b16 v[62:63], v23 offset:512
    v_mfma_f32_16x16x32_bf16 v[168:171], v[64:67], v[96:99], v[168:171]
    s_add_u32 m0, s30, 0
    s_add_u32 s28, s32, 790528
    v_mfma_f32_16x16x32_bf16 v[176:179], v[68:71], v[96:99], v[176:179]
    buffer_load_dwordx4 v11, s[8:11], s28 offen lds
    v_mfma_f32_16x16x32_bf16 v[184:187], v[72:75], v[96:99], v[184:187]
    s_add_u32 m0, s30, 8192
    s_add_u32 s28, s31, 384
    v_mfma_f32_16x16x32_bf16 v[192:195], v[76:79], v[96:99], v[192:195]
    buffer_load_dwordx4 v10, s[4:7], s28 offen lds
    v_mfma_f32_16x16x32_bf16 v[172:175], v[64:67], v[100:103], v[172:175]
    s_add_u32 m0, s30, 16384
    s_add_u32 s28, s31, 131456
    v_mfma_f32_16x16x32_bf16 v[180:183], v[68:71], v[100:103], v[180:183]
    buffer_load_dwordx4 v10, s[4:7], s28 offen lds
    v_mfma_f32_16x16x32_bf16 v[188:191], v[72:75], v[100:103], v[188:191]
    s_add_u32 m0, s30, 24576
    s_add_u32 s28, s31, 262528
    v_mfma_f32_16x16x32_bf16 v[196:199], v[76:79], v[100:103], v[196:199]
    buffer_load_dwordx4 v10, s[4:7], s28 offen lds
    s_waitcnt lgkmcnt(0)
    v_mfma_f32_16x16x32_bf16 v[104:107], v[40:43], v[24:27], v[104:107]
    ds_read_b128 v[64:67], v17 offset:0
    v_mfma_f32_16x16x32_bf16 v[112:115], v[40:43], v[28:31], v[112:115]
    ds_read_b128 v[68:71], v17 offset:2048
    s_add_u32 m0, s30, 32768
    s_add_u32 s28, s31, 393600
    v_mfma_f32_16x16x32_bf16 v[120:123], v[40:43], v[32:35], v[120:123]
    ds_read_b128 v[72:75], v17 offset:4096
    v_mfma_f32_16x16x32_bf16 v[128:131], v[40:43], v[36:39], v[128:131]
    ds_read_b128 v[76:79], v17 offset:6144
    buffer_load_dwordx4 v10, s[4:7], s28 offen lds
    v_mfma_f32_16x16x32_bf16 v[108:111], v[44:47], v[24:27], v[108:111]
    ds_read_b64_tr_b16 v[80:81], v18 offset:4096
    v_mfma_f32_16x16x32_bf16 v[116:119], v[44:47], v[28:31], v[116:119]
    ds_read_b64_tr_b16 v[82:83], v18 offset:4608
    s_add_u32 m0, s30, 40960
    s_add_u32 s28, s32, 1179648
    v_mfma_f32_16x16x32_bf16 v[124:127], v[44:47], v[32:35], v[124:127]
    ds_read_b64_tr_b16 v[84:85], v19 offset:4096
    v_mfma_f32_16x16x32_bf16 v[132:135], v[44:47], v[36:39], v[132:135]
    ds_read_b64_tr_b16 v[86:87], v19 offset:4608
    buffer_load_dwordx4 v11, s[8:11], s28 offen lds
    v_mfma_f32_16x16x32_bf16 v[136:139], v[48:51], v[24:27], v[136:139]
    ds_read_b64_tr_b16 v[88:89], v20 offset:4096
    v_mfma_f32_16x16x32_bf16 v[144:147], v[48:51], v[28:31], v[144:147]
    ds_read_b64_tr_b16 v[90:91], v20 offset:4608
    s_add_u32 m0, s30, 49152
    s_add_u32 s28, s32, 1181696
    v_mfma_f32_16x16x32_bf16 v[152:155], v[48:51], v[32:35], v[152:155]
    ds_read_b64_tr_b16 v[92:93], v21 offset:4096
    v_mfma_f32_16x16x32_bf16 v[160:163], v[48:51], v[36:39], v[160:163]
    ds_read_b64_tr_b16 v[94:95], v21 offset:4608
    buffer_load_dwordx4 v11, s[8:11], s28 offen lds
    v_mfma_f32_16x16x32_bf16 v[140:143], v[52:55], v[24:27], v[140:143]
    s_waitcnt lgkmcnt(8)
    ds_read_b64_tr_b16 v[96:97], v22 offset:4096
    v_mfma_f32_16x16x32_bf16 v[148:151], v[52:55], v[28:31], v[148:151]
    ds_read_b64_tr_b16 v[98:99], v22 offset:4608
    v_mfma_f32_16x16x32_bf16 v[156:159], v[52:55], v[32:35], v[156:159]
    ds_read_b64_tr_b16 v[100:101], v23 offset:4096
    v_mfma_f32_16x16x32_bf16 v[164:167], v[52:55], v[36:39], v[164:167]
    ds_read_b64_tr_b16 v[102:103], v23 offset:4608
    v_mfma_f32_16x16x32_bf16 v[168:171], v[24:27], v[56:59], v[168:171]
    s_add_u32 s33, s34, 114688
    s_cmp_ge_u32 s33, 163840
    s_cselect_b32 s29, 163840, 0
    s_sub_u32 s33, s33, s29
    v_add_u32 v16, s33, v12
    v_mfma_f32_16x16x32_bf16 v[176:179], v[28:31], v[56:59], v[176:179]
    v_add_u32 v17, s33, v13
    v_mfma_f32_16x16x32_bf16 v[184:187], v[32:35], v[56:59], v[184:187]
    v_add_u32 v18, 147456, v14
    v_mfma_f32_16x16x32_bf16 v[192:195], v[36:39], v[56:59], v[192:195]
    v_add_u32 v19, 147456, v15
    v_mfma_f32_16x16x32_bf16 v[172:175], v[24:27], v[60:63], v[172:175]
    v_add_u32 v20, 155648, v14
    v_mfma_f32_16x16x32_bf16 v[180:183], v[28:31], v[60:63], v[180:183]
    v_add_u32 v21, 155648, v15
    v_mfma_f32_16x16x32_bf16 v[188:191], v[32:35], v[60:63], v[188:191]
    v_add_u32 v22, 0, v14
    v_mfma_f32_16x16x32_bf16 v[196:199], v[36:39], v[60:63], v[196:199]
    v_add_u32 v23, 0, v15
    s_cmp_eq_u32 s63, 1
    s_cbranch_scc0 gated_mix__mha_block__softmax_full_mha__prompt_kernel_tc4
    s_mul_i32 s28, s3, 5
    s_add_u32 s28, s28, s101
    buffer_load_dword v219, v218, s[92:95], s28 offen
gated_mix__mha_block__softmax_full_mha__prompt_kernel_tc4:
    v_mov_b32 v216, 0
    v_dot2c_f32_bf16 v216, v200, v208
    v_dot2c_f32_bf16 v216, v201, v209
    v_dot2c_f32_bf16 v216, v202, v210
    v_dot2c_f32_bf16 v216, v203, v211
    v_dot2c_f32_bf16 v216, v204, v212
    v_dot2c_f32_bf16 v216, v205, v213
    v_dot2c_f32_bf16 v216, v206, v214
    v_dot2c_f32_bf16 v216, v207, v215
    s_nop 3
    v_add_f32_dpp v216, v216, v216 row_shr:1 row_mask:0xf bank_mask:0xf
    s_nop 1
    v_add_f32_dpp v216, v216, v216 row_shr:2 row_mask:0xf bank_mask:0xf
    s_nop 1
    v_add_f32_dpp v216, v216, v216 row_shr:4 row_mask:0xf bank_mask:0xf
    s_nop 1
    v_add_f32_dpp v216, v216, v216 row_shr:8 row_mask:0xf bank_mask:0xf
    s_nop 1
    v_add_f32_dpp v216, v216, v216 row_bcast:15 row_mask:0xa bank_mask:0xf
    s_nop 1
    v_add_f32_dpp v216, v216, v216 row_bcast:31 row_mask:0xc bank_mask:0xf
    v_cvt_pk_bf16_f32 v217, v216, v216
    v_lshlrev_b32 v217, 16, v217
    v_mul_f32 v217, 0xbfb8aa3b, v217
    v_exp_f32 v217, v217
    s_nop 0
    v_add_f32 v217, 1.0, v217
    v_rcp_f32 v217, v217
    s_nop 0
    v_cvt_pk_bf16_f32 v217, v217, v217
    v_lshlrev_b32 v9, 16, v217
    s_waitcnt vmcnt(6) lgkmcnt(0)
    s_barrier
    v_mfma_f32_16x16x32_bf16 v[104:107], v[80:83], v[64:67], v[104:107]
    ds_read_b128 v[24:27], v16 offset:0
    v_mfma_f32_16x16x32_bf16 v[112:115], v[80:83], v[68:71], v[112:115]
    ds_read_b128 v[28:31], v16 offset:2048
    v_mfma_f32_16x16x32_bf16 v[120:123], v[80:83], v[72:75], v[120:123]
    ds_read_b128 v[32:35], v16 offset:4096
    v_mfma_f32_16x16x32_bf16 v[128:131], v[80:83], v[76:79], v[128:131]
    ds_read_b128 v[36:39], v16 offset:6144
    v_mfma_f32_16x16x32_bf16 v[108:111], v[84:87], v[64:67], v[108:111]
    ds_read_b64_tr_b16 v[40:41], v18 offset:0
    v_mfma_f32_16x16x32_bf16 v[116:119], v[84:87], v[68:71], v[116:119]
    ds_read_b64_tr_b16 v[42:43], v18 offset:512
    v_mfma_f32_16x16x32_bf16 v[124:127], v[84:87], v[72:75], v[124:127]
    ds_read_b64_tr_b16 v[44:45], v19 offset:0
    v_mfma_f32_16x16x32_bf16 v[132:135], v[84:87], v[76:79], v[132:135]
    ds_read_b64_tr_b16 v[46:47], v19 offset:512
    v_mfma_f32_16x16x32_bf16 v[136:139], v[88:91], v[64:67], v[136:139]
    ds_read_b64_tr_b16 v[48:49], v20 offset:0
    v_mfma_f32_16x16x32_bf16 v[144:147], v[88:91], v[68:71], v[144:147]
    ds_read_b64_tr_b16 v[50:51], v20 offset:512
    v_mfma_f32_16x16x32_bf16 v[152:155], v[88:91], v[72:75], v[152:155]
    ds_read_b64_tr_b16 v[52:53], v21 offset:0
    v_mfma_f32_16x16x32_bf16 v[160:163], v[88:91], v[76:79], v[160:163]
    ds_read_b64_tr_b16 v[54:55], v21 offset:512
    v_mfma_f32_16x16x32_bf16 v[140:143], v[92:95], v[64:67], v[140:143]
    s_waitcnt lgkmcnt(8)
    ds_read_b64_tr_b16 v[56:57], v22 offset:0
    v_mfma_f32_16x16x32_bf16 v[148:151], v[92:95], v[68:71], v[148:151]
    ds_read_b64_tr_b16 v[58:59], v22 offset:512
    v_mfma_f32_16x16x32_bf16 v[156:159], v[92:95], v[72:75], v[156:159]
    ds_read_b64_tr_b16 v[60:61], v23 offset:0
    v_mfma_f32_16x16x32_bf16 v[164:167], v[92:95], v[76:79], v[164:167]
    ds_read_b64_tr_b16 v[62:63], v23 offset:512
    v_mfma_f32_16x16x32_bf16 v[168:171], v[64:67], v[96:99], v[168:171]
    s_add_u32 m0, s30, 57344
    s_add_u32 s28, s32, 1183744
    v_mfma_f32_16x16x32_bf16 v[176:179], v[68:71], v[96:99], v[176:179]
    buffer_load_dwordx4 v11, s[8:11], s28 offen lds
    v_mfma_f32_16x16x32_bf16 v[184:187], v[72:75], v[96:99], v[184:187]
    s_add_u32 m0, s30, 65536
    s_add_u32 s28, s31, 512
    v_mfma_f32_16x16x32_bf16 v[192:195], v[76:79], v[96:99], v[192:195]
    buffer_load_dwordx4 v10, s[4:7], s28 offen lds
    v_mfma_f32_16x16x32_bf16 v[172:175], v[64:67], v[100:103], v[172:175]
    s_add_u32 m0, s30, 73728
    s_add_u32 s28, s31, 131584
    v_mfma_f32_16x16x32_bf16 v[180:183], v[68:71], v[100:103], v[180:183]
    buffer_load_dwordx4 v10, s[4:7], s28 offen lds
    v_mfma_f32_16x16x32_bf16 v[188:191], v[72:75], v[100:103], v[188:191]
    s_add_u32 m0, s30, 81920
    s_add_u32 s28, s31, 262656
    v_mfma_f32_16x16x32_bf16 v[196:199], v[76:79], v[100:103], v[196:199]
    buffer_load_dwordx4 v10, s[4:7], s28 offen lds
    s_waitcnt lgkmcnt(0)
    v_mfma_f32_16x16x32_bf16 v[104:107], v[40:43], v[24:27], v[104:107]
    ds_read_b128 v[64:67], v17 offset:0
    v_mfma_f32_16x16x32_bf16 v[112:115], v[40:43], v[28:31], v[112:115]
    ds_read_b128 v[68:71], v17 offset:2048
    s_add_u32 m0, s30, 90112
    s_add_u32 s28, s31, 393728
    v_mfma_f32_16x16x32_bf16 v[120:123], v[40:43], v[32:35], v[120:123]
    ds_read_b128 v[72:75], v17 offset:4096
    v_mfma_f32_16x16x32_bf16 v[128:131], v[40:43], v[36:39], v[128:131]
    ds_read_b128 v[76:79], v17 offset:6144
    buffer_load_dwordx4 v10, s[4:7], s28 offen lds
    v_mfma_f32_16x16x32_bf16 v[108:111], v[44:47], v[24:27], v[108:111]
    ds_read_b64_tr_b16 v[80:81], v18 offset:4096
    v_mfma_f32_16x16x32_bf16 v[116:119], v[44:47], v[28:31], v[116:119]
    ds_read_b64_tr_b16 v[82:83], v18 offset:4608
    s_add_u32 m0, s30, 98304
    s_add_u32 s28, s32, 1572864
    v_mfma_f32_16x16x32_bf16 v[124:127], v[44:47], v[32:35], v[124:127]
    ds_read_b64_tr_b16 v[84:85], v19 offset:4096
    v_mfma_f32_16x16x32_bf16 v[132:135], v[44:47], v[36:39], v[132:135]
    ds_read_b64_tr_b16 v[86:87], v19 offset:4608
    buffer_load_dwordx4 v11, s[8:11], s28 offen lds
    v_mfma_f32_16x16x32_bf16 v[136:139], v[48:51], v[24:27], v[136:139]
    ds_read_b64_tr_b16 v[88:89], v20 offset:4096
    v_mfma_f32_16x16x32_bf16 v[144:147], v[48:51], v[28:31], v[144:147]
    ds_read_b64_tr_b16 v[90:91], v20 offset:4608
    s_add_u32 m0, s30, 106496
    s_add_u32 s28, s32, 1574912
    v_mfma_f32_16x16x32_bf16 v[152:155], v[48:51], v[32:35], v[152:155]
    ds_read_b64_tr_b16 v[92:93], v21 offset:4096
    v_mfma_f32_16x16x32_bf16 v[160:163], v[48:51], v[36:39], v[160:163]
    ds_read_b64_tr_b16 v[94:95], v21 offset:4608
    buffer_load_dwordx4 v11, s[8:11], s28 offen lds
    v_mfma_f32_16x16x32_bf16 v[140:143], v[52:55], v[24:27], v[140:143]
    s_waitcnt lgkmcnt(8)
    ds_read_b64_tr_b16 v[96:97], v22 offset:4096
    v_mfma_f32_16x16x32_bf16 v[148:151], v[52:55], v[28:31], v[148:151]
    ds_read_b64_tr_b16 v[98:99], v22 offset:4608
    v_mfma_f32_16x16x32_bf16 v[156:159], v[52:55], v[32:35], v[156:159]
    ds_read_b64_tr_b16 v[100:101], v23 offset:4096
    v_mfma_f32_16x16x32_bf16 v[164:167], v[52:55], v[36:39], v[164:167]
    ds_read_b64_tr_b16 v[102:103], v23 offset:4608
    v_mfma_f32_16x16x32_bf16 v[168:171], v[24:27], v[56:59], v[168:171]
    s_add_u32 s33, s34, 8192
    s_cmp_ge_u32 s33, 163840
    s_cselect_b32 s29, 163840, 0
    s_sub_u32 s33, s33, s29
    v_add_u32 v16, s33, v12
    v_mfma_f32_16x16x32_bf16 v[176:179], v[28:31], v[56:59], v[176:179]
    v_add_u32 v17, s33, v13
    v_mfma_f32_16x16x32_bf16 v[184:187], v[32:35], v[56:59], v[184:187]
    v_add_u32 v18, 40960, v14
    v_mfma_f32_16x16x32_bf16 v[192:195], v[36:39], v[56:59], v[192:195]
    v_add_u32 v19, 40960, v15
    v_mfma_f32_16x16x32_bf16 v[172:175], v[24:27], v[60:63], v[172:175]
    v_add_u32 v20, 49152, v14
    v_mfma_f32_16x16x32_bf16 v[180:183], v[28:31], v[60:63], v[180:183]
    v_add_u32 v21, 49152, v15
    v_mfma_f32_16x16x32_bf16 v[188:191], v[32:35], v[60:63], v[188:191]
    v_add_u32 v22, 57344, v14
    v_mfma_f32_16x16x32_bf16 v[196:199], v[36:39], v[60:63], v[196:199]
    v_add_u32 v23, 57344, v15
    s_cmp_eq_u32 s63, 1
    s_cbranch_scc0 gated_mix__mha_block__softmax_full_mha__prompt_kernel_tc5
    s_mul_i32 s28, s3, 6
    s_add_u32 s28, s28, s101
    buffer_load_dword v219, v218, s[92:95], s28 offen
gated_mix__mha_block__softmax_full_mha__prompt_kernel_tc5:
    s_waitcnt vmcnt(6) lgkmcnt(0)
    s_barrier
    v_mfma_f32_16x16x32_bf16 v[104:107], v[80:83], v[64:67], v[104:107]
    ds_read_b128 v[24:27], v16 offset:0
    v_mfma_f32_16x16x32_bf16 v[112:115], v[80:83], v[68:71], v[112:115]
    ds_read_b128 v[28:31], v16 offset:2048
    v_mfma_f32_16x16x32_bf16 v[120:123], v[80:83], v[72:75], v[120:123]
    ds_read_b128 v[32:35], v16 offset:4096
    v_mfma_f32_16x16x32_bf16 v[128:131], v[80:83], v[76:79], v[128:131]
    ds_read_b128 v[36:39], v16 offset:6144
    v_mfma_f32_16x16x32_bf16 v[108:111], v[84:87], v[64:67], v[108:111]
    ds_read_b64_tr_b16 v[40:41], v18 offset:0
    v_mfma_f32_16x16x32_bf16 v[116:119], v[84:87], v[68:71], v[116:119]
    ds_read_b64_tr_b16 v[42:43], v18 offset:512
    v_mfma_f32_16x16x32_bf16 v[124:127], v[84:87], v[72:75], v[124:127]
    ds_read_b64_tr_b16 v[44:45], v19 offset:0
    v_mfma_f32_16x16x32_bf16 v[132:135], v[84:87], v[76:79], v[132:135]
    ds_read_b64_tr_b16 v[46:47], v19 offset:512
    v_mfma_f32_16x16x32_bf16 v[136:139], v[88:91], v[64:67], v[136:139]
    ds_read_b64_tr_b16 v[48:49], v20 offset:0
    v_mfma_f32_16x16x32_bf16 v[144:147], v[88:91], v[68:71], v[144:147]
    ds_read_b64_tr_b16 v[50:51], v20 offset:512
    v_mfma_f32_16x16x32_bf16 v[152:155], v[88:91], v[72:75], v[152:155]
    ds_read_b64_tr_b16 v[52:53], v21 offset:0
    v_mfma_f32_16x16x32_bf16 v[160:163], v[88:91], v[76:79], v[160:163]
    ds_read_b64_tr_b16 v[54:55], v21 offset:512
    v_mfma_f32_16x16x32_bf16 v[140:143], v[92:95], v[64:67], v[140:143]
    s_waitcnt lgkmcnt(8)
    ds_read_b64_tr_b16 v[56:57], v22 offset:0
    v_mfma_f32_16x16x32_bf16 v[148:151], v[92:95], v[68:71], v[148:151]
    ds_read_b64_tr_b16 v[58:59], v22 offset:512
    v_mfma_f32_16x16x32_bf16 v[156:159], v[92:95], v[72:75], v[156:159]
    ds_read_b64_tr_b16 v[60:61], v23 offset:0
    v_mfma_f32_16x16x32_bf16 v[164:167], v[92:95], v[76:79], v[164:167]
    ds_read_b64_tr_b16 v[62:63], v23 offset:512
    v_mfma_f32_16x16x32_bf16 v[168:171], v[64:67], v[96:99], v[168:171]
    s_add_u32 m0, s30, 114688
    s_add_u32 s28, s32, 1576960
    v_mfma_f32_16x16x32_bf16 v[176:179], v[68:71], v[96:99], v[176:179]
    buffer_load_dwordx4 v11, s[8:11], s28 offen lds
    v_mfma_f32_16x16x32_bf16 v[184:187], v[72:75], v[96:99], v[184:187]
    s_add_u32 m0, s30, 122880
    s_add_u32 s28, s31, 640
    v_mfma_f32_16x16x32_bf16 v[192:195], v[76:79], v[96:99], v[192:195]
    buffer_load_dwordx4 v10, s[4:7], s28 offen lds
    v_mfma_f32_16x16x32_bf16 v[172:175], v[64:67], v[100:103], v[172:175]
    s_add_u32 m0, s30, 131072
    s_add_u32 s28, s31, 131712
    v_mfma_f32_16x16x32_bf16 v[180:183], v[68:71], v[100:103], v[180:183]
    buffer_load_dwordx4 v10, s[4:7], s28 offen lds
    v_mfma_f32_16x16x32_bf16 v[188:191], v[72:75], v[100:103], v[188:191]
    s_add_u32 m0, s30, 139264
    s_add_u32 s28, s31, 262784
    v_mfma_f32_16x16x32_bf16 v[196:199], v[76:79], v[100:103], v[196:199]
    buffer_load_dwordx4 v10, s[4:7], s28 offen lds
    s_waitcnt lgkmcnt(0)
    v_mfma_f32_16x16x32_bf16 v[104:107], v[40:43], v[24:27], v[104:107]
    ds_read_b128 v[64:67], v17 offset:0
    v_mfma_f32_16x16x32_bf16 v[112:115], v[40:43], v[28:31], v[112:115]
    ds_read_b128 v[68:71], v17 offset:2048
    s_add_u32 m0, s30, 147456
    s_add_u32 s28, s31, 393856
    v_mfma_f32_16x16x32_bf16 v[120:123], v[40:43], v[32:35], v[120:123]
    ds_read_b128 v[72:75], v17 offset:4096
    v_mfma_f32_16x16x32_bf16 v[128:131], v[40:43], v[36:39], v[128:131]
    ds_read_b128 v[76:79], v17 offset:6144
    buffer_load_dwordx4 v10, s[4:7], s28 offen lds
    v_mfma_f32_16x16x32_bf16 v[108:111], v[44:47], v[24:27], v[108:111]
    ds_read_b64_tr_b16 v[80:81], v18 offset:4096
    v_mfma_f32_16x16x32_bf16 v[116:119], v[44:47], v[28:31], v[116:119]
    ds_read_b64_tr_b16 v[82:83], v18 offset:4608
    s_add_u32 m0, s30, 155648
    s_add_u32 s28, s32, 1966080
    v_mfma_f32_16x16x32_bf16 v[124:127], v[44:47], v[32:35], v[124:127]
    ds_read_b64_tr_b16 v[84:85], v19 offset:4096
    v_mfma_f32_16x16x32_bf16 v[132:135], v[44:47], v[36:39], v[132:135]
    ds_read_b64_tr_b16 v[86:87], v19 offset:4608
    buffer_load_dwordx4 v11, s[8:11], s28 offen lds
    v_mfma_f32_16x16x32_bf16 v[136:139], v[48:51], v[24:27], v[136:139]
    ds_read_b64_tr_b16 v[88:89], v20 offset:4096
    v_mfma_f32_16x16x32_bf16 v[144:147], v[48:51], v[28:31], v[144:147]
    ds_read_b64_tr_b16 v[90:91], v20 offset:4608
    s_add_u32 m0, s30, 0
    s_add_u32 s28, s32, 1968128
    v_mfma_f32_16x16x32_bf16 v[152:155], v[48:51], v[32:35], v[152:155]
    ds_read_b64_tr_b16 v[92:93], v21 offset:4096
    v_mfma_f32_16x16x32_bf16 v[160:163], v[48:51], v[36:39], v[160:163]
    ds_read_b64_tr_b16 v[94:95], v21 offset:4608
    buffer_load_dwordx4 v11, s[8:11], s28 offen lds
    v_mfma_f32_16x16x32_bf16 v[140:143], v[52:55], v[24:27], v[140:143]
    s_waitcnt lgkmcnt(8)
    ds_read_b64_tr_b16 v[96:97], v22 offset:4096
    v_mfma_f32_16x16x32_bf16 v[148:151], v[52:55], v[28:31], v[148:151]
    ds_read_b64_tr_b16 v[98:99], v22 offset:4608
    v_mfma_f32_16x16x32_bf16 v[156:159], v[52:55], v[32:35], v[156:159]
    ds_read_b64_tr_b16 v[100:101], v23 offset:4096
    v_mfma_f32_16x16x32_bf16 v[164:167], v[52:55], v[36:39], v[164:167]
    ds_read_b64_tr_b16 v[102:103], v23 offset:4608
    v_mfma_f32_16x16x32_bf16 v[168:171], v[24:27], v[56:59], v[168:171]
    s_add_u32 s33, s34, 65536
    s_cmp_ge_u32 s33, 163840
    s_cselect_b32 s29, 163840, 0
    s_sub_u32 s33, s33, s29
    v_add_u32 v16, s33, v12
    v_mfma_f32_16x16x32_bf16 v[176:179], v[28:31], v[56:59], v[176:179]
    v_add_u32 v17, s33, v13
    v_mfma_f32_16x16x32_bf16 v[184:187], v[32:35], v[56:59], v[184:187]
    v_add_u32 v18, 98304, v14
    v_mfma_f32_16x16x32_bf16 v[192:195], v[36:39], v[56:59], v[192:195]
    v_add_u32 v19, 98304, v15
    v_mfma_f32_16x16x32_bf16 v[172:175], v[24:27], v[60:63], v[172:175]
    v_add_u32 v20, 106496, v14
    v_mfma_f32_16x16x32_bf16 v[180:183], v[28:31], v[60:63], v[180:183]
    v_add_u32 v21, 106496, v15
    v_mfma_f32_16x16x32_bf16 v[188:191], v[32:35], v[60:63], v[188:191]
    v_add_u32 v22, 114688, v14
    v_mfma_f32_16x16x32_bf16 v[196:199], v[36:39], v[60:63], v[196:199]
    v_add_u32 v23, 114688, v15
    s_cmp_eq_u32 s63, 1
    s_cbranch_scc0 gated_mix__mha_block__softmax_full_mha__prompt_kernel_tc6
    s_mul_i32 s28, s3, 7
    s_add_u32 s28, s28, s101
    buffer_load_dword v219, v218, s[92:95], s28 offen
gated_mix__mha_block__softmax_full_mha__prompt_kernel_tc6:
    s_waitcnt vmcnt(6) lgkmcnt(0)
    s_barrier
    v_mfma_f32_16x16x32_bf16 v[104:107], v[80:83], v[64:67], v[104:107]
    ds_read_b128 v[24:27], v16 offset:0
    v_mfma_f32_16x16x32_bf16 v[112:115], v[80:83], v[68:71], v[112:115]
    ds_read_b128 v[28:31], v16 offset:2048
    v_mfma_f32_16x16x32_bf16 v[120:123], v[80:83], v[72:75], v[120:123]
    ds_read_b128 v[32:35], v16 offset:4096
    v_mfma_f32_16x16x32_bf16 v[128:131], v[80:83], v[76:79], v[128:131]
    ds_read_b128 v[36:39], v16 offset:6144
    v_mfma_f32_16x16x32_bf16 v[108:111], v[84:87], v[64:67], v[108:111]
    ds_read_b64_tr_b16 v[40:41], v18 offset:0
    v_mfma_f32_16x16x32_bf16 v[116:119], v[84:87], v[68:71], v[116:119]
    ds_read_b64_tr_b16 v[42:43], v18 offset:512
    v_mfma_f32_16x16x32_bf16 v[124:127], v[84:87], v[72:75], v[124:127]
    ds_read_b64_tr_b16 v[44:45], v19 offset:0
    v_mfma_f32_16x16x32_bf16 v[132:135], v[84:87], v[76:79], v[132:135]
    ds_read_b64_tr_b16 v[46:47], v19 offset:512
    v_mfma_f32_16x16x32_bf16 v[136:139], v[88:91], v[64:67], v[136:139]
    ds_read_b64_tr_b16 v[48:49], v20 offset:0
    v_mfma_f32_16x16x32_bf16 v[144:147], v[88:91], v[68:71], v[144:147]
    ds_read_b64_tr_b16 v[50:51], v20 offset:512
    v_mfma_f32_16x16x32_bf16 v[152:155], v[88:91], v[72:75], v[152:155]
    ds_read_b64_tr_b16 v[52:53], v21 offset:0
    v_mfma_f32_16x16x32_bf16 v[160:163], v[88:91], v[76:79], v[160:163]
    ds_read_b64_tr_b16 v[54:55], v21 offset:512
    v_mfma_f32_16x16x32_bf16 v[140:143], v[92:95], v[64:67], v[140:143]
    s_waitcnt lgkmcnt(8)
    ds_read_b64_tr_b16 v[56:57], v22 offset:0
    v_mfma_f32_16x16x32_bf16 v[148:151], v[92:95], v[68:71], v[148:151]
    ds_read_b64_tr_b16 v[58:59], v22 offset:512
    v_mfma_f32_16x16x32_bf16 v[156:159], v[92:95], v[72:75], v[156:159]
    ds_read_b64_tr_b16 v[60:61], v23 offset:0
    v_mfma_f32_16x16x32_bf16 v[164:167], v[92:95], v[76:79], v[164:167]
    ds_read_b64_tr_b16 v[62:63], v23 offset:512
    v_mfma_f32_16x16x32_bf16 v[168:171], v[64:67], v[96:99], v[168:171]
    s_add_u32 m0, s30, 8192
    s_add_u32 s28, s32, 1970176
    v_mfma_f32_16x16x32_bf16 v[176:179], v[68:71], v[96:99], v[176:179]
    buffer_load_dwordx4 v11, s[8:11], s28 offen lds
    v_mfma_f32_16x16x32_bf16 v[184:187], v[72:75], v[96:99], v[184:187]
    s_add_u32 m0, s30, 16384
    s_add_u32 s28, s31, 768
    v_mfma_f32_16x16x32_bf16 v[192:195], v[76:79], v[96:99], v[192:195]
    buffer_load_dwordx4 v10, s[4:7], s28 offen lds
    v_mfma_f32_16x16x32_bf16 v[172:175], v[64:67], v[100:103], v[172:175]
    s_add_u32 m0, s30, 24576
    s_add_u32 s28, s31, 131840
    v_mfma_f32_16x16x32_bf16 v[180:183], v[68:71], v[100:103], v[180:183]
    buffer_load_dwordx4 v10, s[4:7], s28 offen lds
    v_mfma_f32_16x16x32_bf16 v[188:191], v[72:75], v[100:103], v[188:191]
    s_add_u32 m0, s30, 32768
    s_add_u32 s28, s31, 262912
    v_mfma_f32_16x16x32_bf16 v[196:199], v[76:79], v[100:103], v[196:199]
    buffer_load_dwordx4 v10, s[4:7], s28 offen lds
    s_waitcnt lgkmcnt(0)
    v_mfma_f32_16x16x32_bf16 v[104:107], v[40:43], v[24:27], v[104:107]
    ds_read_b128 v[64:67], v17 offset:0
    v_mfma_f32_16x16x32_bf16 v[112:115], v[40:43], v[28:31], v[112:115]
    ds_read_b128 v[68:71], v17 offset:2048
    s_add_u32 m0, s30, 40960
    s_add_u32 s28, s31, 393984
    v_mfma_f32_16x16x32_bf16 v[120:123], v[40:43], v[32:35], v[120:123]
    ds_read_b128 v[72:75], v17 offset:4096
    v_mfma_f32_16x16x32_bf16 v[128:131], v[40:43], v[36:39], v[128:131]
    ds_read_b128 v[76:79], v17 offset:6144
    buffer_load_dwordx4 v10, s[4:7], s28 offen lds
    v_mfma_f32_16x16x32_bf16 v[108:111], v[44:47], v[24:27], v[108:111]
    ds_read_b64_tr_b16 v[80:81], v18 offset:4096
    v_mfma_f32_16x16x32_bf16 v[116:119], v[44:47], v[28:31], v[116:119]
    ds_read_b64_tr_b16 v[82:83], v18 offset:4608
    s_add_u32 m0, s30, 49152
    s_add_u32 s28, s32, 2359296
    v_mfma_f32_16x16x32_bf16 v[124:127], v[44:47], v[32:35], v[124:127]
    ds_read_b64_tr_b16 v[84:85], v19 offset:4096
    v_mfma_f32_16x16x32_bf16 v[132:135], v[44:47], v[36:39], v[132:135]
    ds_read_b64_tr_b16 v[86:87], v19 offset:4608
    buffer_load_dwordx4 v11, s[8:11], s28 offen lds
    v_mfma_f32_16x16x32_bf16 v[136:139], v[48:51], v[24:27], v[136:139]
    ds_read_b64_tr_b16 v[88:89], v20 offset:4096
    v_mfma_f32_16x16x32_bf16 v[144:147], v[48:51], v[28:31], v[144:147]
    ds_read_b64_tr_b16 v[90:91], v20 offset:4608
    s_add_u32 m0, s30, 57344
    s_add_u32 s28, s32, 2361344
    v_mfma_f32_16x16x32_bf16 v[152:155], v[48:51], v[32:35], v[152:155]
    ds_read_b64_tr_b16 v[92:93], v21 offset:4096
    v_mfma_f32_16x16x32_bf16 v[160:163], v[48:51], v[36:39], v[160:163]
    ds_read_b64_tr_b16 v[94:95], v21 offset:4608
    buffer_load_dwordx4 v11, s[8:11], s28 offen lds
    v_mfma_f32_16x16x32_bf16 v[140:143], v[52:55], v[24:27], v[140:143]
    s_waitcnt lgkmcnt(8)
    ds_read_b64_tr_b16 v[96:97], v22 offset:4096
    v_mfma_f32_16x16x32_bf16 v[148:151], v[52:55], v[28:31], v[148:151]
    ds_read_b64_tr_b16 v[98:99], v22 offset:4608
    v_mfma_f32_16x16x32_bf16 v[156:159], v[52:55], v[32:35], v[156:159]
    ds_read_b64_tr_b16 v[100:101], v23 offset:4096
    v_mfma_f32_16x16x32_bf16 v[164:167], v[52:55], v[36:39], v[164:167]
    ds_read_b64_tr_b16 v[102:103], v23 offset:4608
    v_mfma_f32_16x16x32_bf16 v[168:171], v[24:27], v[56:59], v[168:171]
    s_add_u32 s33, s34, 122880
    s_cmp_ge_u32 s33, 163840
    s_cselect_b32 s29, 163840, 0
    s_sub_u32 s33, s33, s29
    v_add_u32 v16, s33, v12
    v_mfma_f32_16x16x32_bf16 v[176:179], v[28:31], v[56:59], v[176:179]
    v_add_u32 v17, s33, v13
    v_mfma_f32_16x16x32_bf16 v[184:187], v[32:35], v[56:59], v[184:187]
    v_add_u32 v18, 155648, v14
    v_mfma_f32_16x16x32_bf16 v[192:195], v[36:39], v[56:59], v[192:195]
    v_add_u32 v19, 155648, v15
    v_mfma_f32_16x16x32_bf16 v[172:175], v[24:27], v[60:63], v[172:175]
    v_add_u32 v20, 0, v14
    v_mfma_f32_16x16x32_bf16 v[180:183], v[28:31], v[60:63], v[180:183]
    v_add_u32 v21, 0, v15
    v_mfma_f32_16x16x32_bf16 v[188:191], v[32:35], v[60:63], v[188:191]
    v_add_u32 v22, 8192, v14
    v_mfma_f32_16x16x32_bf16 v[196:199], v[36:39], v[60:63], v[196:199]
    v_add_u32 v23, 8192, v15
    s_cmp_eq_u32 s63, 1
    s_cbranch_scc0 gated_mix__mha_block__softmax_full_mha__prompt_kernel_tc7
    s_mul_i32 s28, s3, 8
    s_add_u32 s28, s28, s101
    buffer_load_dword v219, v218, s[92:95], s28 offen
gated_mix__mha_block__softmax_full_mha__prompt_kernel_tc7:
    s_waitcnt vmcnt(6) lgkmcnt(0)
    s_barrier
    v_mfma_f32_16x16x32_bf16 v[104:107], v[80:83], v[64:67], v[104:107]
    ds_read_b128 v[24:27], v16 offset:0
    v_mfma_f32_16x16x32_bf16 v[112:115], v[80:83], v[68:71], v[112:115]
    ds_read_b128 v[28:31], v16 offset:2048
    v_mfma_f32_16x16x32_bf16 v[120:123], v[80:83], v[72:75], v[120:123]
    ds_read_b128 v[32:35], v16 offset:4096
    v_mfma_f32_16x16x32_bf16 v[128:131], v[80:83], v[76:79], v[128:131]
    ds_read_b128 v[36:39], v16 offset:6144
    v_mfma_f32_16x16x32_bf16 v[108:111], v[84:87], v[64:67], v[108:111]
    ds_read_b64_tr_b16 v[40:41], v18 offset:0
    v_mfma_f32_16x16x32_bf16 v[116:119], v[84:87], v[68:71], v[116:119]
    ds_read_b64_tr_b16 v[42:43], v18 offset:512
    v_mfma_f32_16x16x32_bf16 v[124:127], v[84:87], v[72:75], v[124:127]
    ds_read_b64_tr_b16 v[44:45], v19 offset:0
    v_mfma_f32_16x16x32_bf16 v[132:135], v[84:87], v[76:79], v[132:135]
    ds_read_b64_tr_b16 v[46:47], v19 offset:512
    v_mfma_f32_16x16x32_bf16 v[136:139], v[88:91], v[64:67], v[136:139]
    ds_read_b64_tr_b16 v[48:49], v20 offset:0
    v_mfma_f32_16x16x32_bf16 v[144:147], v[88:91], v[68:71], v[144:147]
    ds_read_b64_tr_b16 v[50:51], v20 offset:512
    v_mfma_f32_16x16x32_bf16 v[152:155], v[88:91], v[72:75], v[152:155]
    ds_read_b64_tr_b16 v[52:53], v21 offset:0
    v_mfma_f32_16x16x32_bf16 v[160:163], v[88:91], v[76:79], v[160:163]
    ds_read_b64_tr_b16 v[54:55], v21 offset:512
    v_mfma_f32_16x16x32_bf16 v[140:143], v[92:95], v[64:67], v[140:143]
    s_waitcnt lgkmcnt(8)
    ds_read_b64_tr_b16 v[56:57], v22 offset:0
    v_mfma_f32_16x16x32_bf16 v[148:151], v[92:95], v[68:71], v[148:151]
    ds_read_b64_tr_b16 v[58:59], v22 offset:512
    v_mfma_f32_16x16x32_bf16 v[156:159], v[92:95], v[72:75], v[156:159]
    ds_read_b64_tr_b16 v[60:61], v23 offset:0
    v_mfma_f32_16x16x32_bf16 v[164:167], v[92:95], v[76:79], v[164:167]
    ds_read_b64_tr_b16 v[62:63], v23 offset:512
    v_mfma_f32_16x16x32_bf16 v[168:171], v[64:67], v[96:99], v[168:171]
    s_add_u32 m0, s30, 65536
    s_add_u32 s28, s32, 2363392
    v_mfma_f32_16x16x32_bf16 v[176:179], v[68:71], v[96:99], v[176:179]
    buffer_load_dwordx4 v11, s[8:11], s28 offen lds
    v_mfma_f32_16x16x32_bf16 v[184:187], v[72:75], v[96:99], v[184:187]
    s_add_u32 m0, s30, 73728
    s_add_u32 s28, s31, 896
    v_mfma_f32_16x16x32_bf16 v[192:195], v[76:79], v[96:99], v[192:195]
    buffer_load_dwordx4 v10, s[4:7], s28 offen lds
    v_mfma_f32_16x16x32_bf16 v[172:175], v[64:67], v[100:103], v[172:175]
    s_add_u32 m0, s30, 81920
    s_add_u32 s28, s31, 131968
    v_mfma_f32_16x16x32_bf16 v[180:183], v[68:71], v[100:103], v[180:183]
    buffer_load_dwordx4 v10, s[4:7], s28 offen lds
    v_mfma_f32_16x16x32_bf16 v[188:191], v[72:75], v[100:103], v[188:191]
    s_add_u32 m0, s30, 90112
    s_add_u32 s28, s31, 263040
    v_mfma_f32_16x16x32_bf16 v[196:199], v[76:79], v[100:103], v[196:199]
    buffer_load_dwordx4 v10, s[4:7], s28 offen lds
    s_waitcnt lgkmcnt(0)
    v_mfma_f32_16x16x32_bf16 v[104:107], v[40:43], v[24:27], v[104:107]
    ds_read_b128 v[64:67], v17 offset:0
    v_mfma_f32_16x16x32_bf16 v[112:115], v[40:43], v[28:31], v[112:115]
    ds_read_b128 v[68:71], v17 offset:2048
    s_add_u32 m0, s30, 98304
    s_add_u32 s28, s31, 394112
    v_mfma_f32_16x16x32_bf16 v[120:123], v[40:43], v[32:35], v[120:123]
    ds_read_b128 v[72:75], v17 offset:4096
    v_mfma_f32_16x16x32_bf16 v[128:131], v[40:43], v[36:39], v[128:131]
    ds_read_b128 v[76:79], v17 offset:6144
    buffer_load_dwordx4 v10, s[4:7], s28 offen lds
    v_mfma_f32_16x16x32_bf16 v[108:111], v[44:47], v[24:27], v[108:111]
    ds_read_b64_tr_b16 v[80:81], v18 offset:4096
    v_mfma_f32_16x16x32_bf16 v[116:119], v[44:47], v[28:31], v[116:119]
    ds_read_b64_tr_b16 v[82:83], v18 offset:4608
    s_add_u32 m0, s30, 106496
    s_add_u32 s28, s32, 2752512
    v_mfma_f32_16x16x32_bf16 v[124:127], v[44:47], v[32:35], v[124:127]
    ds_read_b64_tr_b16 v[84:85], v19 offset:4096
    v_mfma_f32_16x16x32_bf16 v[132:135], v[44:47], v[36:39], v[132:135]
    ds_read_b64_tr_b16 v[86:87], v19 offset:4608
    buffer_load_dwordx4 v11, s[8:11], s28 offen lds
    v_mfma_f32_16x16x32_bf16 v[136:139], v[48:51], v[24:27], v[136:139]
    ds_read_b64_tr_b16 v[88:89], v20 offset:4096
    v_mfma_f32_16x16x32_bf16 v[144:147], v[48:51], v[28:31], v[144:147]
    ds_read_b64_tr_b16 v[90:91], v20 offset:4608
    s_add_u32 m0, s30, 114688
    s_add_u32 s28, s32, 2754560
    v_mfma_f32_16x16x32_bf16 v[152:155], v[48:51], v[32:35], v[152:155]
    ds_read_b64_tr_b16 v[92:93], v21 offset:4096
    v_mfma_f32_16x16x32_bf16 v[160:163], v[48:51], v[36:39], v[160:163]
    ds_read_b64_tr_b16 v[94:95], v21 offset:4608
    buffer_load_dwordx4 v11, s[8:11], s28 offen lds
    v_mfma_f32_16x16x32_bf16 v[140:143], v[52:55], v[24:27], v[140:143]
    s_waitcnt lgkmcnt(8)
    ds_read_b64_tr_b16 v[96:97], v22 offset:4096
    v_mfma_f32_16x16x32_bf16 v[148:151], v[52:55], v[28:31], v[148:151]
    ds_read_b64_tr_b16 v[98:99], v22 offset:4608
    v_mfma_f32_16x16x32_bf16 v[156:159], v[52:55], v[32:35], v[156:159]
    ds_read_b64_tr_b16 v[100:101], v23 offset:4096
    v_mfma_f32_16x16x32_bf16 v[164:167], v[52:55], v[36:39], v[164:167]
    ds_read_b64_tr_b16 v[102:103], v23 offset:4608
    v_mfma_f32_16x16x32_bf16 v[168:171], v[24:27], v[56:59], v[168:171]
    s_add_u32 s33, s34, 16384
    s_cmp_ge_u32 s33, 163840
    s_cselect_b32 s29, 163840, 0
    s_sub_u32 s33, s33, s29
    v_add_u32 v16, s33, v12
    v_mfma_f32_16x16x32_bf16 v[176:179], v[28:31], v[56:59], v[176:179]
    v_add_u32 v17, s33, v13
    v_mfma_f32_16x16x32_bf16 v[184:187], v[32:35], v[56:59], v[184:187]
    v_add_u32 v18, 49152, v14
    v_mfma_f32_16x16x32_bf16 v[192:195], v[36:39], v[56:59], v[192:195]
    v_add_u32 v19, 49152, v15
    v_mfma_f32_16x16x32_bf16 v[172:175], v[24:27], v[60:63], v[172:175]
    v_add_u32 v20, 57344, v14
    v_mfma_f32_16x16x32_bf16 v[180:183], v[28:31], v[60:63], v[180:183]
    v_add_u32 v21, 57344, v15
    v_mfma_f32_16x16x32_bf16 v[188:191], v[32:35], v[60:63], v[188:191]
    v_add_u32 v22, 65536, v14
    v_mfma_f32_16x16x32_bf16 v[196:199], v[36:39], v[60:63], v[196:199]
    v_add_u32 v23, 65536, v15
    s_cmp_eq_u32 s63, 1
    s_cbranch_scc0 gated_mix__mha_block__softmax_full_mha__prompt_kernel_tc8
    s_mul_i32 s28, s3, 9
    s_add_u32 s28, s28, s101
    buffer_load_dword v219, v218, s[92:95], s28 offen
gated_mix__mha_block__softmax_full_mha__prompt_kernel_tc8:
    s_waitcnt vmcnt(6) lgkmcnt(0)
    s_barrier
    v_mfma_f32_16x16x32_bf16 v[104:107], v[80:83], v[64:67], v[104:107]
    ds_read_b128 v[24:27], v16 offset:0
    v_mfma_f32_16x16x32_bf16 v[112:115], v[80:83], v[68:71], v[112:115]
    ds_read_b128 v[28:31], v16 offset:2048
    v_mfma_f32_16x16x32_bf16 v[120:123], v[80:83], v[72:75], v[120:123]
    ds_read_b128 v[32:35], v16 offset:4096
    v_mfma_f32_16x16x32_bf16 v[128:131], v[80:83], v[76:79], v[128:131]
    ds_read_b128 v[36:39], v16 offset:6144
    v_mfma_f32_16x16x32_bf16 v[108:111], v[84:87], v[64:67], v[108:111]
    ds_read_b64_tr_b16 v[40:41], v18 offset:0
    v_mfma_f32_16x16x32_bf16 v[116:119], v[84:87], v[68:71], v[116:119]
    ds_read_b64_tr_b16 v[42:43], v18 offset:512
    v_mfma_f32_16x16x32_bf16 v[124:127], v[84:87], v[72:75], v[124:127]
    ds_read_b64_tr_b16 v[44:45], v19 offset:0
    v_mfma_f32_16x16x32_bf16 v[132:135], v[84:87], v[76:79], v[132:135]
    ds_read_b64_tr_b16 v[46:47], v19 offset:512
    v_mfma_f32_16x16x32_bf16 v[136:139], v[88:91], v[64:67], v[136:139]
    ds_read_b64_tr_b16 v[48:49], v20 offset:0
    v_mfma_f32_16x16x32_bf16 v[144:147], v[88:91], v[68:71], v[144:147]
    ds_read_b64_tr_b16 v[50:51], v20 offset:512
    v_mfma_f32_16x16x32_bf16 v[152:155], v[88:91], v[72:75], v[152:155]
    ds_read_b64_tr_b16 v[52:53], v21 offset:0
    v_mfma_f32_16x16x32_bf16 v[160:163], v[88:91], v[76:79], v[160:163]
    ds_read_b64_tr_b16 v[54:55], v21 offset:512
    v_mfma_f32_16x16x32_bf16 v[140:143], v[92:95], v[64:67], v[140:143]
    s_waitcnt lgkmcnt(8)
    ds_read_b64_tr_b16 v[56:57], v22 offset:0
    v_mfma_f32_16x16x32_bf16 v[148:151], v[92:95], v[68:71], v[148:151]
    ds_read_b64_tr_b16 v[58:59], v22 offset:512
    v_mfma_f32_16x16x32_bf16 v[156:159], v[92:95], v[72:75], v[156:159]
    ds_read_b64_tr_b16 v[60:61], v23 offset:0
    v_mfma_f32_16x16x32_bf16 v[164:167], v[92:95], v[76:79], v[164:167]
    ds_read_b64_tr_b16 v[62:63], v23 offset:512
    v_mfma_f32_16x16x32_bf16 v[168:171], v[64:67], v[96:99], v[168:171]
    s_add_u32 m0, s30, 122880
    s_add_u32 s28, s32, 2756608
    v_mfma_f32_16x16x32_bf16 v[176:179], v[68:71], v[96:99], v[176:179]
    buffer_load_dwordx4 v11, s[8:11], s28 offen lds
    v_mfma_f32_16x16x32_bf16 v[184:187], v[72:75], v[96:99], v[184:187]
    s_add_u32 m0, s30, 131072
    s_add_u32 s28, s31, 1024
    v_mfma_f32_16x16x32_bf16 v[192:195], v[76:79], v[96:99], v[192:195]
    buffer_load_dwordx4 v10, s[4:7], s28 offen lds
    v_mfma_f32_16x16x32_bf16 v[172:175], v[64:67], v[100:103], v[172:175]
    s_add_u32 m0, s30, 139264
    s_add_u32 s28, s31, 132096
    v_mfma_f32_16x16x32_bf16 v[180:183], v[68:71], v[100:103], v[180:183]
    buffer_load_dwordx4 v10, s[4:7], s28 offen lds
    v_mfma_f32_16x16x32_bf16 v[188:191], v[72:75], v[100:103], v[188:191]
    s_add_u32 m0, s30, 147456
    s_add_u32 s28, s31, 263168
    v_mfma_f32_16x16x32_bf16 v[196:199], v[76:79], v[100:103], v[196:199]
    buffer_load_dwordx4 v10, s[4:7], s28 offen lds
    s_waitcnt lgkmcnt(0)
    v_mfma_f32_16x16x32_bf16 v[104:107], v[40:43], v[24:27], v[104:107]
    ds_read_b128 v[64:67], v17 offset:0
    v_mfma_f32_16x16x32_bf16 v[112:115], v[40:43], v[28:31], v[112:115]
    ds_read_b128 v[68:71], v17 offset:2048
    s_add_u32 m0, s30, 155648
    s_add_u32 s28, s31, 394240
    v_mfma_f32_16x16x32_bf16 v[120:123], v[40:43], v[32:35], v[120:123]
    ds_read_b128 v[72:75], v17 offset:4096
    v_mfma_f32_16x16x32_bf16 v[128:131], v[40:43], v[36:39], v[128:131]
    ds_read_b128 v[76:79], v17 offset:6144
    buffer_load_dwordx4 v10, s[4:7], s28 offen lds
    v_mfma_f32_16x16x32_bf16 v[108:111], v[44:47], v[24:27], v[108:111]
    ds_read_b64_tr_b16 v[80:81], v18 offset:4096
    v_mfma_f32_16x16x32_bf16 v[116:119], v[44:47], v[28:31], v[116:119]
    ds_read_b64_tr_b16 v[82:83], v18 offset:4608
    s_add_u32 m0, s30, 0
    s_add_u32 s28, s32, 3145728
    v_mfma_f32_16x16x32_bf16 v[124:127], v[44:47], v[32:35], v[124:127]
    ds_read_b64_tr_b16 v[84:85], v19 offset:4096
    v_mfma_f32_16x16x32_bf16 v[132:135], v[44:47], v[36:39], v[132:135]
    ds_read_b64_tr_b16 v[86:87], v19 offset:4608
    buffer_load_dwordx4 v11, s[8:11], s28 offen lds
    v_mfma_f32_16x16x32_bf16 v[136:139], v[48:51], v[24:27], v[136:139]
    ds_read_b64_tr_b16 v[88:89], v20 offset:4096
    v_mfma_f32_16x16x32_bf16 v[144:147], v[48:51], v[28:31], v[144:147]
    ds_read_b64_tr_b16 v[90:91], v20 offset:4608
    s_add_u32 m0, s30, 8192
    s_add_u32 s28, s32, 3147776
    v_mfma_f32_16x16x32_bf16 v[152:155], v[48:51], v[32:35], v[152:155]
    ds_read_b64_tr_b16 v[92:93], v21 offset:4096
    v_mfma_f32_16x16x32_bf16 v[160:163], v[48:51], v[36:39], v[160:163]
    ds_read_b64_tr_b16 v[94:95], v21 offset:4608
    buffer_load_dwordx4 v11, s[8:11], s28 offen lds
    v_mfma_f32_16x16x32_bf16 v[140:143], v[52:55], v[24:27], v[140:143]
    s_waitcnt lgkmcnt(8)
    ds_read_b64_tr_b16 v[96:97], v22 offset:4096
    v_mfma_f32_16x16x32_bf16 v[148:151], v[52:55], v[28:31], v[148:151]
    ds_read_b64_tr_b16 v[98:99], v22 offset:4608
    v_mfma_f32_16x16x32_bf16 v[156:159], v[52:55], v[32:35], v[156:159]
    ds_read_b64_tr_b16 v[100:101], v23 offset:4096
    v_mfma_f32_16x16x32_bf16 v[164:167], v[52:55], v[36:39], v[164:167]
    ds_read_b64_tr_b16 v[102:103], v23 offset:4608
    v_mfma_f32_16x16x32_bf16 v[168:171], v[24:27], v[56:59], v[168:171]
    s_add_u32 s33, s34, 73728
    s_cmp_ge_u32 s33, 163840
    s_cselect_b32 s29, 163840, 0
    s_sub_u32 s33, s33, s29
    v_add_u32 v16, s33, v12
    v_mfma_f32_16x16x32_bf16 v[176:179], v[28:31], v[56:59], v[176:179]
    v_add_u32 v17, s33, v13
    v_mfma_f32_16x16x32_bf16 v[184:187], v[32:35], v[56:59], v[184:187]
    v_add_u32 v18, 106496, v14
    v_mfma_f32_16x16x32_bf16 v[192:195], v[36:39], v[56:59], v[192:195]
    v_add_u32 v19, 106496, v15
    v_mfma_f32_16x16x32_bf16 v[172:175], v[24:27], v[60:63], v[172:175]
    v_add_u32 v20, 114688, v14
    v_mfma_f32_16x16x32_bf16 v[180:183], v[28:31], v[60:63], v[180:183]
    v_add_u32 v21, 114688, v15
    v_mfma_f32_16x16x32_bf16 v[188:191], v[32:35], v[60:63], v[188:191]
    v_add_u32 v22, 122880, v14
    v_mfma_f32_16x16x32_bf16 v[196:199], v[36:39], v[60:63], v[196:199]
    v_add_u32 v23, 122880, v15
    s_cmp_eq_u32 s63, 1
    s_cbranch_scc0 gated_mix__mha_block__softmax_full_mha__prompt_kernel_tc9
    s_mul_i32 s28, s3, 10
    s_add_u32 s28, s28, s101
    buffer_load_dword v219, v218, s[92:95], s28 offen
gated_mix__mha_block__softmax_full_mha__prompt_kernel_tc9:
    s_waitcnt vmcnt(6) lgkmcnt(0)
    s_barrier
    v_mfma_f32_16x16x32_bf16 v[104:107], v[80:83], v[64:67], v[104:107]
    ds_read_b128 v[24:27], v16 offset:0
    v_mfma_f32_16x16x32_bf16 v[112:115], v[80:83], v[68:71], v[112:115]
    ds_read_b128 v[28:31], v16 offset:2048
    v_mfma_f32_16x16x32_bf16 v[120:123], v[80:83], v[72:75], v[120:123]
    ds_read_b128 v[32:35], v16 offset:4096
    v_mfma_f32_16x16x32_bf16 v[128:131], v[80:83], v[76:79], v[128:131]
    ds_read_b128 v[36:39], v16 offset:6144
    v_mfma_f32_16x16x32_bf16 v[108:111], v[84:87], v[64:67], v[108:111]
    ds_read_b64_tr_b16 v[40:41], v18 offset:0
    v_mfma_f32_16x16x32_bf16 v[116:119], v[84:87], v[68:71], v[116:119]
    ds_read_b64_tr_b16 v[42:43], v18 offset:512
    v_mfma_f32_16x16x32_bf16 v[124:127], v[84:87], v[72:75], v[124:127]
    ds_read_b64_tr_b16 v[44:45], v19 offset:0
    v_mfma_f32_16x16x32_bf16 v[132:135], v[84:87], v[76:79], v[132:135]
    ds_read_b64_tr_b16 v[46:47], v19 offset:512
    v_mfma_f32_16x16x32_bf16 v[136:139], v[88:91], v[64:67], v[136:139]
    ds_read_b64_tr_b16 v[48:49], v20 offset:0
    v_mfma_f32_16x16x32_bf16 v[144:147], v[88:91], v[68:71], v[144:147]
    ds_read_b64_tr_b16 v[50:51], v20 offset:512
    v_mfma_f32_16x16x32_bf16 v[152:155], v[88:91], v[72:75], v[152:155]
    ds_read_b64_tr_b16 v[52:53], v21 offset:0
    v_mfma_f32_16x16x32_bf16 v[160:163], v[88:91], v[76:79], v[160:163]
    ds_read_b64_tr_b16 v[54:55], v21 offset:512
    v_mfma_f32_16x16x32_bf16 v[140:143], v[92:95], v[64:67], v[140:143]
    s_waitcnt lgkmcnt(8)
    ds_read_b64_tr_b16 v[56:57], v22 offset:0
    v_mfma_f32_16x16x32_bf16 v[148:151], v[92:95], v[68:71], v[148:151]
    ds_read_b64_tr_b16 v[58:59], v22 offset:512
    v_mfma_f32_16x16x32_bf16 v[156:159], v[92:95], v[72:75], v[156:159]
    ds_read_b64_tr_b16 v[60:61], v23 offset:0
    v_mfma_f32_16x16x32_bf16 v[164:167], v[92:95], v[76:79], v[164:167]
    ds_read_b64_tr_b16 v[62:63], v23 offset:512
    v_mfma_f32_16x16x32_bf16 v[168:171], v[64:67], v[96:99], v[168:171]
    s_add_u32 m0, s30, 16384
    s_add_u32 s28, s32, 3149824
    v_mfma_f32_16x16x32_bf16 v[176:179], v[68:71], v[96:99], v[176:179]
    buffer_load_dwordx4 v11, s[8:11], s28 offen lds
    v_mfma_f32_16x16x32_bf16 v[184:187], v[72:75], v[96:99], v[184:187]
    s_add_u32 m0, s30, 24576
    s_add_u32 s28, s31, 1152
    v_mfma_f32_16x16x32_bf16 v[192:195], v[76:79], v[96:99], v[192:195]
    buffer_load_dwordx4 v10, s[4:7], s28 offen lds
    v_mfma_f32_16x16x32_bf16 v[172:175], v[64:67], v[100:103], v[172:175]
    s_add_u32 m0, s30, 32768
    s_add_u32 s28, s31, 132224
    v_mfma_f32_16x16x32_bf16 v[180:183], v[68:71], v[100:103], v[180:183]
    buffer_load_dwordx4 v10, s[4:7], s28 offen lds
    v_mfma_f32_16x16x32_bf16 v[188:191], v[72:75], v[100:103], v[188:191]
    s_add_u32 m0, s30, 40960
    s_add_u32 s28, s31, 263296
    v_mfma_f32_16x16x32_bf16 v[196:199], v[76:79], v[100:103], v[196:199]
    buffer_load_dwordx4 v10, s[4:7], s28 offen lds
    s_waitcnt lgkmcnt(0)
    v_mfma_f32_16x16x32_bf16 v[104:107], v[40:43], v[24:27], v[104:107]
    ds_read_b128 v[64:67], v17 offset:0
    v_mfma_f32_16x16x32_bf16 v[112:115], v[40:43], v[28:31], v[112:115]
    ds_read_b128 v[68:71], v17 offset:2048
    s_add_u32 m0, s30, 49152
    s_add_u32 s28, s31, 394368
    v_mfma_f32_16x16x32_bf16 v[120:123], v[40:43], v[32:35], v[120:123]
    ds_read_b128 v[72:75], v17 offset:4096
    v_mfma_f32_16x16x32_bf16 v[128:131], v[40:43], v[36:39], v[128:131]
    ds_read_b128 v[76:79], v17 offset:6144
    buffer_load_dwordx4 v10, s[4:7], s28 offen lds
    v_mfma_f32_16x16x32_bf16 v[108:111], v[44:47], v[24:27], v[108:111]
    ds_read_b64_tr_b16 v[80:81], v18 offset:4096
    v_mfma_f32_16x16x32_bf16 v[116:119], v[44:47], v[28:31], v[116:119]
    ds_read_b64_tr_b16 v[82:83], v18 offset:4608
    s_add_u32 m0, s30, 57344
    s_add_u32 s28, s32, 3538944
    v_mfma_f32_16x16x32_bf16 v[124:127], v[44:47], v[32:35], v[124:127]
    ds_read_b64_tr_b16 v[84:85], v19 offset:4096
    v_mfma_f32_16x16x32_bf16 v[132:135], v[44:47], v[36:39], v[132:135]
    ds_read_b64_tr_b16 v[86:87], v19 offset:4608
    buffer_load_dwordx4 v11, s[8:11], s28 offen lds
    v_mfma_f32_16x16x32_bf16 v[136:139], v[48:51], v[24:27], v[136:139]
    ds_read_b64_tr_b16 v[88:89], v20 offset:4096
    v_mfma_f32_16x16x32_bf16 v[144:147], v[48:51], v[28:31], v[144:147]
    ds_read_b64_tr_b16 v[90:91], v20 offset:4608
    s_add_u32 m0, s30, 65536
    s_add_u32 s28, s32, 3540992
    v_mfma_f32_16x16x32_bf16 v[152:155], v[48:51], v[32:35], v[152:155]
    ds_read_b64_tr_b16 v[92:93], v21 offset:4096
    v_mfma_f32_16x16x32_bf16 v[160:163], v[48:51], v[36:39], v[160:163]
    ds_read_b64_tr_b16 v[94:95], v21 offset:4608
    buffer_load_dwordx4 v11, s[8:11], s28 offen lds
    v_mfma_f32_16x16x32_bf16 v[140:143], v[52:55], v[24:27], v[140:143]
    s_waitcnt lgkmcnt(8)
    ds_read_b64_tr_b16 v[96:97], v22 offset:4096
    v_mfma_f32_16x16x32_bf16 v[148:151], v[52:55], v[28:31], v[148:151]
    ds_read_b64_tr_b16 v[98:99], v22 offset:4608
    v_mfma_f32_16x16x32_bf16 v[156:159], v[52:55], v[32:35], v[156:159]
    ds_read_b64_tr_b16 v[100:101], v23 offset:4096
    v_mfma_f32_16x16x32_bf16 v[164:167], v[52:55], v[36:39], v[164:167]
    ds_read_b64_tr_b16 v[102:103], v23 offset:4608
    v_mfma_f32_16x16x32_bf16 v[168:171], v[24:27], v[56:59], v[168:171]
    s_add_u32 s33, s34, 131072
    s_cmp_ge_u32 s33, 163840
    s_cselect_b32 s29, 163840, 0
    s_sub_u32 s33, s33, s29
    v_add_u32 v16, s33, v12
    v_mfma_f32_16x16x32_bf16 v[176:179], v[28:31], v[56:59], v[176:179]
    v_add_u32 v17, s33, v13
    v_mfma_f32_16x16x32_bf16 v[184:187], v[32:35], v[56:59], v[184:187]
    v_add_u32 v18, 0, v14
    v_mfma_f32_16x16x32_bf16 v[192:195], v[36:39], v[56:59], v[192:195]
    v_add_u32 v19, 0, v15
    v_mfma_f32_16x16x32_bf16 v[172:175], v[24:27], v[60:63], v[172:175]
    v_add_u32 v20, 8192, v14
    v_mfma_f32_16x16x32_bf16 v[180:183], v[28:31], v[60:63], v[180:183]
    v_add_u32 v21, 8192, v15
    v_mfma_f32_16x16x32_bf16 v[188:191], v[32:35], v[60:63], v[188:191]
    v_add_u32 v22, 16384, v14
    v_mfma_f32_16x16x32_bf16 v[196:199], v[36:39], v[60:63], v[196:199]
    v_add_u32 v23, 16384, v15
    s_cmp_eq_u32 s63, 1
    s_cbranch_scc0 gated_mix__mha_block__softmax_full_mha__prompt_kernel_tc10
    s_mul_i32 s28, s3, 11
    s_add_u32 s28, s28, s101
    buffer_load_dword v219, v218, s[92:95], s28 offen
gated_mix__mha_block__softmax_full_mha__prompt_kernel_tc10:
    s_waitcnt vmcnt(6) lgkmcnt(0)
    s_barrier
    s_and_b32 s28, s2, 3
    s_lshl_b32 s28, s28, 6
    v_mov_b32 v243, s28
    s_cmp_eq_u32 s20, 0
    s_cbranch_scc0 gated_mix__mha_block__softmax_full_mha__prompt_kernel_np
    buffer_load_dword v244, v243, s[36:39], 0 offen sc1
gated_mix__mha_block__softmax_full_mha__prompt_kernel_np:
    v_mfma_f32_16x16x32_bf16 v[104:107], v[80:83], v[64:67], v[104:107]
    ds_read_b128 v[24:27], v16 offset:0
    v_mfma_f32_16x16x32_bf16 v[112:115], v[80:83], v[68:71], v[112:115]
    ds_read_b128 v[28:31], v16 offset:2048
    v_mfma_f32_16x16x32_bf16 v[120:123], v[80:83], v[72:75], v[120:123]
    ds_read_b128 v[32:35], v16 offset:4096
    v_mfma_f32_16x16x32_bf16 v[128:131], v[80:83], v[76:79], v[128:131]
    ds_read_b128 v[36:39], v16 offset:6144
    v_mfma_f32_16x16x32_bf16 v[108:111], v[84:87], v[64:67], v[108:111]
    ds_read_b64_tr_b16 v[40:41], v18 offset:0
    v_mfma_f32_16x16x32_bf16 v[116:119], v[84:87], v[68:71], v[116:119]
    ds_read_b64_tr_b16 v[42:43], v18 offset:512
    v_mfma_f32_16x16x32_bf16 v[124:127], v[84:87], v[72:75], v[124:127]
    ds_read_b64_tr_b16 v[44:45], v19 offset:0
    v_mfma_f32_16x16x32_bf16 v[132:135], v[84:87], v[76:79], v[132:135]
    ds_read_b64_tr_b16 v[46:47], v19 offset:512
    v_mfma_f32_16x16x32_bf16 v[136:139], v[88:91], v[64:67], v[136:139]
    ds_read_b64_tr_b16 v[48:49], v20 offset:0
    v_mfma_f32_16x16x32_bf16 v[144:147], v[88:91], v[68:71], v[144:147]
    ds_read_b64_tr_b16 v[50:51], v20 offset:512
    v_mfma_f32_16x16x32_bf16 v[152:155], v[88:91], v[72:75], v[152:155]
    ds_read_b64_tr_b16 v[52:53], v21 offset:0
    v_mfma_f32_16x16x32_bf16 v[160:163], v[88:91], v[76:79], v[160:163]
    ds_read_b64_tr_b16 v[54:55], v21 offset:512
    v_mfma_f32_16x16x32_bf16 v[140:143], v[92:95], v[64:67], v[140:143]
    s_waitcnt lgkmcnt(8)
    ds_read_b64_tr_b16 v[56:57], v22 offset:0
    v_mfma_f32_16x16x32_bf16 v[148:151], v[92:95], v[68:71], v[148:151]
    ds_read_b64_tr_b16 v[58:59], v22 offset:512
    v_mfma_f32_16x16x32_bf16 v[156:159], v[92:95], v[72:75], v[156:159]
    ds_read_b64_tr_b16 v[60:61], v23 offset:0
    v_mfma_f32_16x16x32_bf16 v[164:167], v[92:95], v[76:79], v[164:167]
    ds_read_b64_tr_b16 v[62:63], v23 offset:512
    v_mfma_f32_16x16x32_bf16 v[168:171], v[64:67], v[96:99], v[168:171]
    s_add_u32 m0, s30, 73728
    s_add_u32 s28, s32, 3543040
    v_mfma_f32_16x16x32_bf16 v[176:179], v[68:71], v[96:99], v[176:179]
    buffer_load_dwordx4 v11, s[8:11], s28 offen lds
    v_mfma_f32_16x16x32_bf16 v[184:187], v[72:75], v[96:99], v[184:187]
    s_add_u32 m0, s30, 81920
    s_add_u32 s28, s31, 1280
    v_mfma_f32_16x16x32_bf16 v[192:195], v[76:79], v[96:99], v[192:195]
    buffer_load_dwordx4 v10, s[4:7], s28 offen lds
    v_mfma_f32_16x16x32_bf16 v[172:175], v[64:67], v[100:103], v[172:175]
    s_add_u32 m0, s30, 90112
    s_add_u32 s28, s31, 132352
    v_mfma_f32_16x16x32_bf16 v[180:183], v[68:71], v[100:103], v[180:183]
    buffer_load_dwordx4 v10, s[4:7], s28 offen lds
    v_mfma_f32_16x16x32_bf16 v[188:191], v[72:75], v[100:103], v[188:191]
    s_add_u32 m0, s30, 98304
    s_add_u32 s28, s31, 263424
    v_mfma_f32_16x16x32_bf16 v[196:199], v[76:79], v[100:103], v[196:199]
    buffer_load_dwordx4 v10, s[4:7], s28 offen lds
    s_waitcnt lgkmcnt(0)
    v_mfma_f32_16x16x32_bf16 v[104:107], v[40:43], v[24:27], v[104:107]
    ds_read_b128 v[64:67], v17 offset:0
    v_mfma_f32_16x16x32_bf16 v[112:115], v[40:43], v[28:31], v[112:115]
    ds_read_b128 v[68:71], v17 offset:2048
    s_add_u32 m0, s30, 106496
    s_add_u32 s28, s31, 394496
    v_mfma_f32_16x16x32_bf16 v[120:123], v[40:43], v[32:35], v[120:123]
    ds_read_b128 v[72:75], v17 offset:4096
    v_mfma_f32_16x16x32_bf16 v[128:131], v[40:43], v[36:39], v[128:131]
    ds_read_b128 v[76:79], v17 offset:6144
    buffer_load_dwordx4 v10, s[4:7], s28 offen lds
    v_mfma_f32_16x16x32_bf16 v[108:111], v[44:47], v[24:27], v[108:111]
    ds_read_b64_tr_b16 v[80:81], v18 offset:4096
    v_mfma_f32_16x16x32_bf16 v[116:119], v[44:47], v[28:31], v[116:119]
    ds_read_b64_tr_b16 v[82:83], v18 offset:4608
    s_add_u32 m0, s30, 114688
    s_add_u32 s28, s32, 3932160
    v_mfma_f32_16x16x32_bf16 v[124:127], v[44:47], v[32:35], v[124:127]
    ds_read_b64_tr_b16 v[84:85], v19 offset:4096
    v_mfma_f32_16x16x32_bf16 v[132:135], v[44:47], v[36:39], v[132:135]
    ds_read_b64_tr_b16 v[86:87], v19 offset:4608
    buffer_load_dwordx4 v11, s[8:11], s28 offen lds
    v_mfma_f32_16x16x32_bf16 v[136:139], v[48:51], v[24:27], v[136:139]
    ds_read_b64_tr_b16 v[88:89], v20 offset:4096
    v_mfma_f32_16x16x32_bf16 v[144:147], v[48:51], v[28:31], v[144:147]
    ds_read_b64_tr_b16 v[90:91], v20 offset:4608
    s_add_u32 m0, s30, 122880
    s_add_u32 s28, s32, 3934208
    v_mfma_f32_16x16x32_bf16 v[152:155], v[48:51], v[32:35], v[152:155]
    ds_read_b64_tr_b16 v[92:93], v21 offset:4096
    v_mfma_f32_16x16x32_bf16 v[160:163], v[48:51], v[36:39], v[160:163]
    ds_read_b64_tr_b16 v[94:95], v21 offset:4608
    buffer_load_dwordx4 v11, s[8:11], s28 offen lds
    v_mfma_f32_16x16x32_bf16 v[140:143], v[52:55], v[24:27], v[140:143]
    s_waitcnt lgkmcnt(8)
    ds_read_b64_tr_b16 v[96:97], v22 offset:4096
    v_mfma_f32_16x16x32_bf16 v[148:151], v[52:55], v[28:31], v[148:151]
    ds_read_b64_tr_b16 v[98:99], v22 offset:4608
    v_mfma_f32_16x16x32_bf16 v[156:159], v[52:55], v[32:35], v[156:159]
    ds_read_b64_tr_b16 v[100:101], v23 offset:4096
    v_mfma_f32_16x16x32_bf16 v[164:167], v[52:55], v[36:39], v[164:167]
    ds_read_b64_tr_b16 v[102:103], v23 offset:4608
    v_mfma_f32_16x16x32_bf16 v[168:171], v[24:27], v[56:59], v[168:171]
    s_add_u32 s33, s34, 24576
    s_cmp_ge_u32 s33, 163840
    s_cselect_b32 s29, 163840, 0
    s_sub_u32 s33, s33, s29
    v_add_u32 v16, s33, v12
    v_mfma_f32_16x16x32_bf16 v[176:179], v[28:31], v[56:59], v[176:179]
    v_add_u32 v17, s33, v13
    v_mfma_f32_16x16x32_bf16 v[184:187], v[32:35], v[56:59], v[184:187]
    v_add_u32 v18, 57344, v14
    v_mfma_f32_16x16x32_bf16 v[192:195], v[36:39], v[56:59], v[192:195]
    v_add_u32 v19, 57344, v15
    v_mfma_f32_16x16x32_bf16 v[172:175], v[24:27], v[60:63], v[172:175]
    v_add_u32 v20, 65536, v14
    v_mfma_f32_16x16x32_bf16 v[180:183], v[28:31], v[60:63], v[180:183]
    v_add_u32 v21, 65536, v15
    v_mfma_f32_16x16x32_bf16 v[188:191], v[32:35], v[60:63], v[188:191]
    v_add_u32 v22, 73728, v14
    v_mfma_f32_16x16x32_bf16 v[196:199], v[36:39], v[60:63], v[196:199]
    v_add_u32 v23, 73728, v15
    s_cmp_eq_u32 s63, 1
    s_cbranch_scc0 gated_mix__mha_block__softmax_full_mha__prompt_kernel_tc11
    s_mul_i32 s28, s3, 12
    s_add_u32 s28, s28, s101
    buffer_load_dword v219, v218, s[92:95], s28 offen
gated_mix__mha_block__softmax_full_mha__prompt_kernel_tc11:
    s_waitcnt vmcnt(6) lgkmcnt(0)
    s_barrier
    v_mfma_f32_16x16x32_bf16 v[104:107], v[80:83], v[64:67], v[104:107]
    ds_read_b128 v[24:27], v16 offset:0
    v_mfma_f32_16x16x32_bf16 v[112:115], v[80:83], v[68:71], v[112:115]
    ds_read_b128 v[28:31], v16 offset:2048
    v_mfma_f32_16x16x32_bf16 v[120:123], v[80:83], v[72:75], v[120:123]
    ds_read_b128 v[32:35], v16 offset:4096
    v_mfma_f32_16x16x32_bf16 v[128:131], v[80:83], v[76:79], v[128:131]
    ds_read_b128 v[36:39], v16 offset:6144
    v_mfma_f32_16x16x32_bf16 v[108:111], v[84:87], v[64:67], v[108:111]
    ds_read_b64_tr_b16 v[40:41], v18 offset:0
    v_mfma_f32_16x16x32_bf16 v[116:119], v[84:87], v[68:71], v[116:119]
    ds_read_b64_tr_b16 v[42:43], v18 offset:512
    v_mfma_f32_16x16x32_bf16 v[124:127], v[84:87], v[72:75], v[124:127]
    ds_read_b64_tr_b16 v[44:45], v19 offset:0
    v_mfma_f32_16x16x32_bf16 v[132:135], v[84:87], v[76:79], v[132:135]
    ds_read_b64_tr_b16 v[46:47], v19 offset:512
    v_mfma_f32_16x16x32_bf16 v[136:139], v[88:91], v[64:67], v[136:139]
    ds_read_b64_tr_b16 v[48:49], v20 offset:0
    v_mfma_f32_16x16x32_bf16 v[144:147], v[88:91], v[68:71], v[144:147]
    ds_read_b64_tr_b16 v[50:51], v20 offset:512
    v_mfma_f32_16x16x32_bf16 v[152:155], v[88:91], v[72:75], v[152:155]
    ds_read_b64_tr_b16 v[52:53], v21 offset:0
    v_mfma_f32_16x16x32_bf16 v[160:163], v[88:91], v[76:79], v[160:163]
    ds_read_b64_tr_b16 v[54:55], v21 offset:512
    v_mfma_f32_16x16x32_bf16 v[140:143], v[92:95], v[64:67], v[140:143]
    s_waitcnt lgkmcnt(8)
    ds_read_b64_tr_b16 v[56:57], v22 offset:0
    v_mfma_f32_16x16x32_bf16 v[148:151], v[92:95], v[68:71], v[148:151]
    ds_read_b64_tr_b16 v[58:59], v22 offset:512
    v_mfma_f32_16x16x32_bf16 v[156:159], v[92:95], v[72:75], v[156:159]
    ds_read_b64_tr_b16 v[60:61], v23 offset:0
    v_mfma_f32_16x16x32_bf16 v[164:167], v[92:95], v[76:79], v[164:167]
    ds_read_b64_tr_b16 v[62:63], v23 offset:512
    v_mfma_f32_16x16x32_bf16 v[168:171], v[64:67], v[96:99], v[168:171]
    s_add_u32 m0, s30, 131072
    s_add_u32 s28, s32, 3936256
    v_mfma_f32_16x16x32_bf16 v[176:179], v[68:71], v[96:99], v[176:179]
    buffer_load_dwordx4 v11, s[8:11], s28 offen lds
    v_mfma_f32_16x16x32_bf16 v[184:187], v[72:75], v[96:99], v[184:187]
    s_add_u32 m0, s30, 139264
    s_add_u32 s28, s31, 1408
    v_mfma_f32_16x16x32_bf16 v[192:195], v[76:79], v[96:99], v[192:195]
    buffer_load_dwordx4 v10, s[4:7], s28 offen lds
    v_mfma_f32_16x16x32_bf16 v[172:175], v[64:67], v[100:103], v[172:175]
    s_add_u32 m0, s30, 147456
    s_add_u32 s28, s31, 132480
    v_mfma_f32_16x16x32_bf16 v[180:183], v[68:71], v[100:103], v[180:183]
    buffer_load_dwordx4 v10, s[4:7], s28 offen lds
    v_mfma_f32_16x16x32_bf16 v[188:191], v[72:75], v[100:103], v[188:191]
    s_add_u32 m0, s30, 155648
    s_add_u32 s28, s31, 263552
    v_mfma_f32_16x16x32_bf16 v[196:199], v[76:79], v[100:103], v[196:199]
    buffer_load_dwordx4 v10, s[4:7], s28 offen lds
    s_waitcnt lgkmcnt(0)
    v_mfma_f32_16x16x32_bf16 v[104:107], v[40:43], v[24:27], v[104:107]
    ds_read_b128 v[64:67], v17 offset:0
    v_mfma_f32_16x16x32_bf16 v[112:115], v[40:43], v[28:31], v[112:115]
    ds_read_b128 v[68:71], v17 offset:2048
    s_add_u32 m0, s30, 0
    s_add_u32 s28, s31, 394624
    v_mfma_f32_16x16x32_bf16 v[120:123], v[40:43], v[32:35], v[120:123]
    ds_read_b128 v[72:75], v17 offset:4096
    v_mfma_f32_16x16x32_bf16 v[128:131], v[40:43], v[36:39], v[128:131]
    ds_read_b128 v[76:79], v17 offset:6144
    buffer_load_dwordx4 v10, s[4:7], s28 offen lds
    v_mfma_f32_16x16x32_bf16 v[108:111], v[44:47], v[24:27], v[108:111]
    ds_read_b64_tr_b16 v[80:81], v18 offset:4096
    v_mfma_f32_16x16x32_bf16 v[116:119], v[44:47], v[28:31], v[116:119]
    ds_read_b64_tr_b16 v[82:83], v18 offset:4608
    s_add_u32 m0, s30, 8192
    s_add_u32 s28, s32, 4325376
    v_mfma_f32_16x16x32_bf16 v[124:127], v[44:47], v[32:35], v[124:127]
    ds_read_b64_tr_b16 v[84:85], v19 offset:4096
    v_mfma_f32_16x16x32_bf16 v[132:135], v[44:47], v[36:39], v[132:135]
    ds_read_b64_tr_b16 v[86:87], v19 offset:4608
    buffer_load_dwordx4 v11, s[8:11], s28 offen lds
    v_mfma_f32_16x16x32_bf16 v[136:139], v[48:51], v[24:27], v[136:139]
    ds_read_b64_tr_b16 v[88:89], v20 offset:4096
    v_mfma_f32_16x16x32_bf16 v[144:147], v[48:51], v[28:31], v[144:147]
    ds_read_b64_tr_b16 v[90:91], v20 offset:4608
    s_add_u32 m0, s30, 16384
    s_add_u32 s28, s32, 4327424
    v_mfma_f32_16x16x32_bf16 v[152:155], v[48:51], v[32:35], v[152:155]
    ds_read_b64_tr_b16 v[92:93], v21 offset:4096
    v_mfma_f32_16x16x32_bf16 v[160:163], v[48:51], v[36:39], v[160:163]
    ds_read_b64_tr_b16 v[94:95], v21 offset:4608
    buffer_load_dwordx4 v11, s[8:11], s28 offen lds
    v_mfma_f32_16x16x32_bf16 v[140:143], v[52:55], v[24:27], v[140:143]
    s_waitcnt lgkmcnt(8)
    ds_read_b64_tr_b16 v[96:97], v22 offset:4096
    v_mfma_f32_16x16x32_bf16 v[148:151], v[52:55], v[28:31], v[148:151]
    ds_read_b64_tr_b16 v[98:99], v22 offset:4608
    v_mfma_f32_16x16x32_bf16 v[156:159], v[52:55], v[32:35], v[156:159]
    ds_read_b64_tr_b16 v[100:101], v23 offset:4096
    v_mfma_f32_16x16x32_bf16 v[164:167], v[52:55], v[36:39], v[164:167]
    ds_read_b64_tr_b16 v[102:103], v23 offset:4608
    v_mfma_f32_16x16x32_bf16 v[168:171], v[24:27], v[56:59], v[168:171]
    s_add_u32 s33, s34, 81920
    s_cmp_ge_u32 s33, 163840
    s_cselect_b32 s29, 163840, 0
    s_sub_u32 s33, s33, s29
    v_add_u32 v16, s33, v12
    v_mfma_f32_16x16x32_bf16 v[176:179], v[28:31], v[56:59], v[176:179]
    v_add_u32 v17, s33, v13
    v_mfma_f32_16x16x32_bf16 v[184:187], v[32:35], v[56:59], v[184:187]
    v_add_u32 v18, 114688, v14
    v_mfma_f32_16x16x32_bf16 v[192:195], v[36:39], v[56:59], v[192:195]
    v_add_u32 v19, 114688, v15
    v_mfma_f32_16x16x32_bf16 v[172:175], v[24:27], v[60:63], v[172:175]
    v_add_u32 v20, 122880, v14
    v_mfma_f32_16x16x32_bf16 v[180:183], v[28:31], v[60:63], v[180:183]
    v_add_u32 v21, 122880, v15
    v_mfma_f32_16x16x32_bf16 v[188:191], v[32:35], v[60:63], v[188:191]
    v_add_u32 v22, 131072, v14
    v_mfma_f32_16x16x32_bf16 v[196:199], v[36:39], v[60:63], v[196:199]
    v_add_u32 v23, 131072, v15
    s_cmp_eq_u32 s63, 1
    s_cbranch_scc0 gated_mix__mha_block__softmax_full_mha__prompt_kernel_tc12
    s_mul_i32 s28, s3, 13
    s_add_u32 s28, s28, s101
    buffer_load_dword v219, v218, s[92:95], s28 offen
gated_mix__mha_block__softmax_full_mha__prompt_kernel_tc12:
    s_waitcnt vmcnt(6) lgkmcnt(0)
    s_barrier
    v_mfma_f32_16x16x32_bf16 v[104:107], v[80:83], v[64:67], v[104:107]
    ds_read_b128 v[24:27], v16 offset:0
    v_mfma_f32_16x16x32_bf16 v[112:115], v[80:83], v[68:71], v[112:115]
    ds_read_b128 v[28:31], v16 offset:2048
    v_mfma_f32_16x16x32_bf16 v[120:123], v[80:83], v[72:75], v[120:123]
    ds_read_b128 v[32:35], v16 offset:4096
    v_mfma_f32_16x16x32_bf16 v[128:131], v[80:83], v[76:79], v[128:131]
    ds_read_b128 v[36:39], v16 offset:6144
    v_mfma_f32_16x16x32_bf16 v[108:111], v[84:87], v[64:67], v[108:111]
    ds_read_b64_tr_b16 v[40:41], v18 offset:0
    v_mfma_f32_16x16x32_bf16 v[116:119], v[84:87], v[68:71], v[116:119]
    ds_read_b64_tr_b16 v[42:43], v18 offset:512
    v_mfma_f32_16x16x32_bf16 v[124:127], v[84:87], v[72:75], v[124:127]
    ds_read_b64_tr_b16 v[44:45], v19 offset:0
    v_mfma_f32_16x16x32_bf16 v[132:135], v[84:87], v[76:79], v[132:135]
    ds_read_b64_tr_b16 v[46:47], v19 offset:512
    v_mfma_f32_16x16x32_bf16 v[136:139], v[88:91], v[64:67], v[136:139]
    ds_read_b64_tr_b16 v[48:49], v20 offset:0
    v_mfma_f32_16x16x32_bf16 v[144:147], v[88:91], v[68:71], v[144:147]
    ds_read_b64_tr_b16 v[50:51], v20 offset:512
    v_mfma_f32_16x16x32_bf16 v[152:155], v[88:91], v[72:75], v[152:155]
    ds_read_b64_tr_b16 v[52:53], v21 offset:0
    v_mfma_f32_16x16x32_bf16 v[160:163], v[88:91], v[76:79], v[160:163]
    ds_read_b64_tr_b16 v[54:55], v21 offset:512
    v_mfma_f32_16x16x32_bf16 v[140:143], v[92:95], v[64:67], v[140:143]
    s_waitcnt lgkmcnt(8)
    ds_read_b64_tr_b16 v[56:57], v22 offset:0
    v_mfma_f32_16x16x32_bf16 v[148:151], v[92:95], v[68:71], v[148:151]
    ds_read_b64_tr_b16 v[58:59], v22 offset:512
    v_mfma_f32_16x16x32_bf16 v[156:159], v[92:95], v[72:75], v[156:159]
    ds_read_b64_tr_b16 v[60:61], v23 offset:0
    v_mfma_f32_16x16x32_bf16 v[164:167], v[92:95], v[76:79], v[164:167]
    ds_read_b64_tr_b16 v[62:63], v23 offset:512
    v_mfma_f32_16x16x32_bf16 v[168:171], v[64:67], v[96:99], v[168:171]
    s_add_u32 m0, s30, 24576
    s_add_u32 s28, s32, 4329472
    v_mfma_f32_16x16x32_bf16 v[176:179], v[68:71], v[96:99], v[176:179]
    buffer_load_dwordx4 v11, s[8:11], s28 offen lds
    v_mfma_f32_16x16x32_bf16 v[184:187], v[72:75], v[96:99], v[184:187]
    s_add_u32 m0, s30, 32768
    s_add_u32 s28, s31, 1536
    v_mfma_f32_16x16x32_bf16 v[192:195], v[76:79], v[96:99], v[192:195]
    buffer_load_dwordx4 v10, s[4:7], s28 offen lds
    v_mfma_f32_16x16x32_bf16 v[172:175], v[64:67], v[100:103], v[172:175]
    s_add_u32 m0, s30, 40960
    s_add_u32 s28, s31, 132608
    v_mfma_f32_16x16x32_bf16 v[180:183], v[68:71], v[100:103], v[180:183]
    buffer_load_dwordx4 v10, s[4:7], s28 offen lds
    v_mfma_f32_16x16x32_bf16 v[188:191], v[72:75], v[100:103], v[188:191]
    s_add_u32 m0, s30, 49152
    s_add_u32 s28, s31, 263680
    v_mfma_f32_16x16x32_bf16 v[196:199], v[76:79], v[100:103], v[196:199]
    buffer_load_dwordx4 v10, s[4:7], s28 offen lds
    s_waitcnt lgkmcnt(0)
    v_mfma_f32_16x16x32_bf16 v[104:107], v[40:43], v[24:27], v[104:107]
    ds_read_b128 v[64:67], v17 offset:0
    v_mfma_f32_16x16x32_bf16 v[112:115], v[40:43], v[28:31], v[112:115]
    ds_read_b128 v[68:71], v17 offset:2048
    s_add_u32 m0, s30, 57344
    s_add_u32 s28, s31, 394752
    v_mfma_f32_16x16x32_bf16 v[120:123], v[40:43], v[32:35], v[120:123]
    ds_read_b128 v[72:75], v17 offset:4096
    v_mfma_f32_16x16x32_bf16 v[128:131], v[40:43], v[36:39], v[128:131]
    ds_read_b128 v[76:79], v17 offset:6144
    buffer_load_dwordx4 v10, s[4:7], s28 offen lds
    v_mfma_f32_16x16x32_bf16 v[108:111], v[44:47], v[24:27], v[108:111]
    ds_read_b64_tr_b16 v[80:81], v18 offset:4096
    v_mfma_f32_16x16x32_bf16 v[116:119], v[44:47], v[28:31], v[116:119]
    ds_read_b64_tr_b16 v[82:83], v18 offset:4608
    s_add_u32 m0, s30, 65536
    s_add_u32 s28, s32, 4718592
    v_mfma_f32_16x16x32_bf16 v[124:127], v[44:47], v[32:35], v[124:127]
    ds_read_b64_tr_b16 v[84:85], v19 offset:4096
    v_mfma_f32_16x16x32_bf16 v[132:135], v[44:47], v[36:39], v[132:135]
    ds_read_b64_tr_b16 v[86:87], v19 offset:4608
    buffer_load_dwordx4 v11, s[8:11], s28 offen lds
    v_mfma_f32_16x16x32_bf16 v[136:139], v[48:51], v[24:27], v[136:139]
    ds_read_b64_tr_b16 v[88:89], v20 offset:4096
    v_mfma_f32_16x16x32_bf16 v[144:147], v[48:51], v[28:31], v[144:147]
    ds_read_b64_tr_b16 v[90:91], v20 offset:4608
    s_add_u32 m0, s30, 73728
    s_add_u32 s28, s32, 4720640
    v_mfma_f32_16x16x32_bf16 v[152:155], v[48:51], v[32:35], v[152:155]
    ds_read_b64_tr_b16 v[92:93], v21 offset:4096
    v_mfma_f32_16x16x32_bf16 v[160:163], v[48:51], v[36:39], v[160:163]
    ds_read_b64_tr_b16 v[94:95], v21 offset:4608
    buffer_load_dwordx4 v11, s[8:11], s28 offen lds
    v_mfma_f32_16x16x32_bf16 v[140:143], v[52:55], v[24:27], v[140:143]
    s_waitcnt lgkmcnt(8)
    ds_read_b64_tr_b16 v[96:97], v22 offset:4096
    v_mfma_f32_16x16x32_bf16 v[148:151], v[52:55], v[28:31], v[148:151]
    ds_read_b64_tr_b16 v[98:99], v22 offset:4608
    v_mfma_f32_16x16x32_bf16 v[156:159], v[52:55], v[32:35], v[156:159]
    ds_read_b64_tr_b16 v[100:101], v23 offset:4096
    v_mfma_f32_16x16x32_bf16 v[164:167], v[52:55], v[36:39], v[164:167]
    ds_read_b64_tr_b16 v[102:103], v23 offset:4608
    v_mfma_f32_16x16x32_bf16 v[168:171], v[24:27], v[56:59], v[168:171]
    s_add_u32 s33, s34, 139264
    s_cmp_ge_u32 s33, 163840
    s_cselect_b32 s29, 163840, 0
    s_sub_u32 s33, s33, s29
    v_add_u32 v16, s33, v12
    v_mfma_f32_16x16x32_bf16 v[176:179], v[28:31], v[56:59], v[176:179]
    v_add_u32 v17, s33, v13
    v_mfma_f32_16x16x32_bf16 v[184:187], v[32:35], v[56:59], v[184:187]
    v_add_u32 v18, 8192, v14
    v_mfma_f32_16x16x32_bf16 v[192:195], v[36:39], v[56:59], v[192:195]
    v_add_u32 v19, 8192, v15
    v_mfma_f32_16x16x32_bf16 v[172:175], v[24:27], v[60:63], v[172:175]
    v_add_u32 v20, 16384, v14
    v_mfma_f32_16x16x32_bf16 v[180:183], v[28:31], v[60:63], v[180:183]
    v_add_u32 v21, 16384, v15
    v_mfma_f32_16x16x32_bf16 v[188:191], v[32:35], v[60:63], v[188:191]
    v_add_u32 v22, 24576, v14
    v_mfma_f32_16x16x32_bf16 v[196:199], v[36:39], v[60:63], v[196:199]
    v_add_u32 v23, 24576, v15
    s_cmp_eq_u32 s63, 1
    s_cbranch_scc0 gated_mix__mha_block__softmax_full_mha__prompt_kernel_tc13
    s_mul_i32 s28, s3, 14
    s_add_u32 s28, s28, s101
    buffer_load_dword v219, v218, s[92:95], s28 offen
gated_mix__mha_block__softmax_full_mha__prompt_kernel_tc13:
    s_waitcnt vmcnt(6) lgkmcnt(0)
    s_barrier
    v_mfma_f32_16x16x32_bf16 v[104:107], v[80:83], v[64:67], v[104:107]
    ds_read_b128 v[24:27], v16 offset:0
    v_mfma_f32_16x16x32_bf16 v[112:115], v[80:83], v[68:71], v[112:115]
    ds_read_b128 v[28:31], v16 offset:2048
    v_mfma_f32_16x16x32_bf16 v[120:123], v[80:83], v[72:75], v[120:123]
    ds_read_b128 v[32:35], v16 offset:4096
    v_mfma_f32_16x16x32_bf16 v[128:131], v[80:83], v[76:79], v[128:131]
    ds_read_b128 v[36:39], v16 offset:6144
    v_mfma_f32_16x16x32_bf16 v[108:111], v[84:87], v[64:67], v[108:111]
    ds_read_b64_tr_b16 v[40:41], v18 offset:0
    v_mfma_f32_16x16x32_bf16 v[116:119], v[84:87], v[68:71], v[116:119]
    ds_read_b64_tr_b16 v[42:43], v18 offset:512
    v_mfma_f32_16x16x32_bf16 v[124:127], v[84:87], v[72:75], v[124:127]
    ds_read_b64_tr_b16 v[44:45], v19 offset:0
    v_mfma_f32_16x16x32_bf16 v[132:135], v[84:87], v[76:79], v[132:135]
    ds_read_b64_tr_b16 v[46:47], v19 offset:512
    v_mfma_f32_16x16x32_bf16 v[136:139], v[88:91], v[64:67], v[136:139]
    ds_read_b64_tr_b16 v[48:49], v20 offset:0
    v_mfma_f32_16x16x32_bf16 v[144:147], v[88:91], v[68:71], v[144:147]
    ds_read_b64_tr_b16 v[50:51], v20 offset:512
    v_mfma_f32_16x16x32_bf16 v[152:155], v[88:91], v[72:75], v[152:155]
    ds_read_b64_tr_b16 v[52:53], v21 offset:0
    v_mfma_f32_16x16x32_bf16 v[160:163], v[88:91], v[76:79], v[160:163]
    ds_read_b64_tr_b16 v[54:55], v21 offset:512
    v_mfma_f32_16x16x32_bf16 v[140:143], v[92:95], v[64:67], v[140:143]
    s_waitcnt lgkmcnt(8)
    ds_read_b64_tr_b16 v[56:57], v22 offset:0
    v_mfma_f32_16x16x32_bf16 v[148:151], v[92:95], v[68:71], v[148:151]
    ds_read_b64_tr_b16 v[58:59], v22 offset:512
    v_mfma_f32_16x16x32_bf16 v[156:159], v[92:95], v[72:75], v[156:159]
    ds_read_b64_tr_b16 v[60:61], v23 offset:0
    v_mfma_f32_16x16x32_bf16 v[164:167], v[92:95], v[76:79], v[164:167]
    ds_read_b64_tr_b16 v[62:63], v23 offset:512
    v_mfma_f32_16x16x32_bf16 v[168:171], v[64:67], v[96:99], v[168:171]
    s_add_u32 m0, s30, 81920
    s_add_u32 s28, s32, 4722688
    v_mfma_f32_16x16x32_bf16 v[176:179], v[68:71], v[96:99], v[176:179]
    buffer_load_dwordx4 v11, s[8:11], s28 offen lds
    v_mfma_f32_16x16x32_bf16 v[184:187], v[72:75], v[96:99], v[184:187]
    s_add_u32 m0, s30, 90112
    s_add_u32 s28, s31, 1664
    v_mfma_f32_16x16x32_bf16 v[192:195], v[76:79], v[96:99], v[192:195]
    buffer_load_dwordx4 v10, s[4:7], s28 offen lds
    v_mfma_f32_16x16x32_bf16 v[172:175], v[64:67], v[100:103], v[172:175]
    s_add_u32 m0, s30, 98304
    s_add_u32 s28, s31, 132736
    v_mfma_f32_16x16x32_bf16 v[180:183], v[68:71], v[100:103], v[180:183]
    buffer_load_dwordx4 v10, s[4:7], s28 offen lds
    v_mfma_f32_16x16x32_bf16 v[188:191], v[72:75], v[100:103], v[188:191]
    s_add_u32 m0, s30, 106496
    s_add_u32 s28, s31, 263808
    v_mfma_f32_16x16x32_bf16 v[196:199], v[76:79], v[100:103], v[196:199]
    buffer_load_dwordx4 v10, s[4:7], s28 offen lds
    s_waitcnt lgkmcnt(0)
    v_mfma_f32_16x16x32_bf16 v[104:107], v[40:43], v[24:27], v[104:107]
    ds_read_b128 v[64:67], v17 offset:0
    v_mfma_f32_16x16x32_bf16 v[112:115], v[40:43], v[28:31], v[112:115]
    ds_read_b128 v[68:71], v17 offset:2048
    s_add_u32 m0, s30, 114688
    s_add_u32 s28, s31, 394880
    v_mfma_f32_16x16x32_bf16 v[120:123], v[40:43], v[32:35], v[120:123]
    ds_read_b128 v[72:75], v17 offset:4096
    v_mfma_f32_16x16x32_bf16 v[128:131], v[40:43], v[36:39], v[128:131]
    ds_read_b128 v[76:79], v17 offset:6144
    buffer_load_dwordx4 v10, s[4:7], s28 offen lds
    v_mfma_f32_16x16x32_bf16 v[108:111], v[44:47], v[24:27], v[108:111]
    ds_read_b64_tr_b16 v[80:81], v18 offset:4096
    v_mfma_f32_16x16x32_bf16 v[116:119], v[44:47], v[28:31], v[116:119]
    ds_read_b64_tr_b16 v[82:83], v18 offset:4608
    s_add_u32 m0, s30, 122880
    s_add_u32 s28, s32, 5111808
    v_mfma_f32_16x16x32_bf16 v[124:127], v[44:47], v[32:35], v[124:127]
    ds_read_b64_tr_b16 v[84:85], v19 offset:4096
    v_mfma_f32_16x16x32_bf16 v[132:135], v[44:47], v[36:39], v[132:135]
    ds_read_b64_tr_b16 v[86:87], v19 offset:4608
    buffer_load_dwordx4 v11, s[8:11], s28 offen lds
    v_mfma_f32_16x16x32_bf16 v[136:139], v[48:51], v[24:27], v[136:139]
    ds_read_b64_tr_b16 v[88:89], v20 offset:4096
    v_mfma_f32_16x16x32_bf16 v[144:147], v[48:51], v[28:31], v[144:147]
    ds_read_b64_tr_b16 v[90:91], v20 offset:4608
    s_add_u32 m0, s30, 131072
    s_add_u32 s28, s32, 5113856
    v_mfma_f32_16x16x32_bf16 v[152:155], v[48:51], v[32:35], v[152:155]
    ds_read_b64_tr_b16 v[92:93], v21 offset:4096
    v_mfma_f32_16x16x32_bf16 v[160:163], v[48:51], v[36:39], v[160:163]
    ds_read_b64_tr_b16 v[94:95], v21 offset:4608
    buffer_load_dwordx4 v11, s[8:11], s28 offen lds
    v_mfma_f32_16x16x32_bf16 v[140:143], v[52:55], v[24:27], v[140:143]
    s_waitcnt lgkmcnt(8)
    ds_read_b64_tr_b16 v[96:97], v22 offset:4096
    v_mfma_f32_16x16x32_bf16 v[148:151], v[52:55], v[28:31], v[148:151]
    ds_read_b64_tr_b16 v[98:99], v22 offset:4608
    v_mfma_f32_16x16x32_bf16 v[156:159], v[52:55], v[32:35], v[156:159]
    ds_read_b64_tr_b16 v[100:101], v23 offset:4096
    v_mfma_f32_16x16x32_bf16 v[164:167], v[52:55], v[36:39], v[164:167]
    ds_read_b64_tr_b16 v[102:103], v23 offset:4608
    v_mfma_f32_16x16x32_bf16 v[168:171], v[24:27], v[56:59], v[168:171]
    s_add_u32 s33, s34, 32768
    s_cmp_ge_u32 s33, 163840
    s_cselect_b32 s29, 163840, 0
    s_sub_u32 s33, s33, s29
    v_add_u32 v16, s33, v12
    v_mfma_f32_16x16x32_bf16 v[176:179], v[28:31], v[56:59], v[176:179]
    v_add_u32 v17, s33, v13
    v_mfma_f32_16x16x32_bf16 v[184:187], v[32:35], v[56:59], v[184:187]
    v_add_u32 v18, 65536, v14
    v_mfma_f32_16x16x32_bf16 v[192:195], v[36:39], v[56:59], v[192:195]
    v_add_u32 v19, 65536, v15
    v_mfma_f32_16x16x32_bf16 v[172:175], v[24:27], v[60:63], v[172:175]
    v_add_u32 v20, 73728, v14
    v_mfma_f32_16x16x32_bf16 v[180:183], v[28:31], v[60:63], v[180:183]
    v_add_u32 v21, 73728, v15
    v_mfma_f32_16x16x32_bf16 v[188:191], v[32:35], v[60:63], v[188:191]
    v_add_u32 v22, 81920, v14
    v_mfma_f32_16x16x32_bf16 v[196:199], v[36:39], v[60:63], v[196:199]
    v_add_u32 v23, 81920, v15
    s_cmp_eq_u32 s63, 1
    s_cbranch_scc0 gated_mix__mha_block__softmax_full_mha__prompt_kernel_tc14
    s_mul_i32 s28, s3, 15
    s_add_u32 s28, s28, s101
    buffer_load_dword v219, v218, s[92:95], s28 offen
gated_mix__mha_block__softmax_full_mha__prompt_kernel_tc14:
    s_waitcnt vmcnt(6) lgkmcnt(0)
    s_barrier
    v_mfma_f32_16x16x32_bf16 v[104:107], v[80:83], v[64:67], v[104:107]
    ds_read_b128 v[24:27], v16 offset:0
    v_mfma_f32_16x16x32_bf16 v[112:115], v[80:83], v[68:71], v[112:115]
    ds_read_b128 v[28:31], v16 offset:2048
    v_mfma_f32_16x16x32_bf16 v[120:123], v[80:83], v[72:75], v[120:123]
    ds_read_b128 v[32:35], v16 offset:4096
    v_mfma_f32_16x16x32_bf16 v[128:131], v[80:83], v[76:79], v[128:131]
    ds_read_b128 v[36:39], v16 offset:6144
    v_mfma_f32_16x16x32_bf16 v[108:111], v[84:87], v[64:67], v[108:111]
    ds_read_b64_tr_b16 v[40:41], v18 offset:0
    v_mfma_f32_16x16x32_bf16 v[116:119], v[84:87], v[68:71], v[116:119]
    ds_read_b64_tr_b16 v[42:43], v18 offset:512
    v_mfma_f32_16x16x32_bf16 v[124:127], v[84:87], v[72:75], v[124:127]
    ds_read_b64_tr_b16 v[44:45], v19 offset:0
    v_mfma_f32_16x16x32_bf16 v[132:135], v[84:87], v[76:79], v[132:135]
    ds_read_b64_tr_b16 v[46:47], v19 offset:512
    v_mfma_f32_16x16x32_bf16 v[136:139], v[88:91], v[64:67], v[136:139]
    ds_read_b64_tr_b16 v[48:49], v20 offset:0
    v_mfma_f32_16x16x32_bf16 v[144:147], v[88:91], v[68:71], v[144:147]
    ds_read_b64_tr_b16 v[50:51], v20 offset:512
    v_mfma_f32_16x16x32_bf16 v[152:155], v[88:91], v[72:75], v[152:155]
    ds_read_b64_tr_b16 v[52:53], v21 offset:0
    v_mfma_f32_16x16x32_bf16 v[160:163], v[88:91], v[76:79], v[160:163]
    ds_read_b64_tr_b16 v[54:55], v21 offset:512
    v_mfma_f32_16x16x32_bf16 v[140:143], v[92:95], v[64:67], v[140:143]
    s_waitcnt lgkmcnt(8)
    ds_read_b64_tr_b16 v[56:57], v22 offset:0
    v_mfma_f32_16x16x32_bf16 v[148:151], v[92:95], v[68:71], v[148:151]
    ds_read_b64_tr_b16 v[58:59], v22 offset:512
    v_mfma_f32_16x16x32_bf16 v[156:159], v[92:95], v[72:75], v[156:159]
    ds_read_b64_tr_b16 v[60:61], v23 offset:0
    v_mfma_f32_16x16x32_bf16 v[164:167], v[92:95], v[76:79], v[164:167]
    ds_read_b64_tr_b16 v[62:63], v23 offset:512
    v_mfma_f32_16x16x32_bf16 v[168:171], v[64:67], v[96:99], v[168:171]
    s_add_u32 m0, s30, 139264
    s_add_u32 s28, s32, 5115904
    v_mfma_f32_16x16x32_bf16 v[176:179], v[68:71], v[96:99], v[176:179]
    buffer_load_dwordx4 v11, s[8:11], s28 offen lds
    v_mfma_f32_16x16x32_bf16 v[184:187], v[72:75], v[96:99], v[184:187]
    s_add_u32 m0, s30, 147456
    s_add_u32 s28, s31, 1792
    v_mfma_f32_16x16x32_bf16 v[192:195], v[76:79], v[96:99], v[192:195]
    buffer_load_dwordx4 v10, s[4:7], s28 offen lds
    v_mfma_f32_16x16x32_bf16 v[172:175], v[64:67], v[100:103], v[172:175]
    s_add_u32 m0, s30, 155648
    s_add_u32 s28, s31, 132864
    v_mfma_f32_16x16x32_bf16 v[180:183], v[68:71], v[100:103], v[180:183]
    buffer_load_dwordx4 v10, s[4:7], s28 offen lds
    v_mfma_f32_16x16x32_bf16 v[188:191], v[72:75], v[100:103], v[188:191]
    s_add_u32 m0, s30, 0
    s_add_u32 s28, s31, 263936
    v_mfma_f32_16x16x32_bf16 v[196:199], v[76:79], v[100:103], v[196:199]
    buffer_load_dwordx4 v10, s[4:7], s28 offen lds
    s_waitcnt lgkmcnt(0)
    v_mfma_f32_16x16x32_bf16 v[104:107], v[40:43], v[24:27], v[104:107]
    ds_read_b128 v[64:67], v17 offset:0
    v_mfma_f32_16x16x32_bf16 v[112:115], v[40:43], v[28:31], v[112:115]
    ds_read_b128 v[68:71], v17 offset:2048
    s_add_u32 m0, s30, 8192
    s_add_u32 s28, s31, 395008
    v_mfma_f32_16x16x32_bf16 v[120:123], v[40:43], v[32:35], v[120:123]
    ds_read_b128 v[72:75], v17 offset:4096
    v_mfma_f32_16x16x32_bf16 v[128:131], v[40:43], v[36:39], v[128:131]
    ds_read_b128 v[76:79], v17 offset:6144
    buffer_load_dwordx4 v10, s[4:7], s28 offen lds
    v_mfma_f32_16x16x32_bf16 v[108:111], v[44:47], v[24:27], v[108:111]
    ds_read_b64_tr_b16 v[80:81], v18 offset:4096
    v_mfma_f32_16x16x32_bf16 v[116:119], v[44:47], v[28:31], v[116:119]
    ds_read_b64_tr_b16 v[82:83], v18 offset:4608
    s_add_u32 m0, s30, 16384
    s_add_u32 s28, s32, 5505024
    v_mfma_f32_16x16x32_bf16 v[124:127], v[44:47], v[32:35], v[124:127]
    ds_read_b64_tr_b16 v[84:85], v19 offset:4096
    v_mfma_f32_16x16x32_bf16 v[132:135], v[44:47], v[36:39], v[132:135]
    ds_read_b64_tr_b16 v[86:87], v19 offset:4608
    buffer_load_dwordx4 v11, s[8:11], s28 offen lds
    v_mfma_f32_16x16x32_bf16 v[136:139], v[48:51], v[24:27], v[136:139]
    ds_read_b64_tr_b16 v[88:89], v20 offset:4096
    v_mfma_f32_16x16x32_bf16 v[144:147], v[48:51], v[28:31], v[144:147]
    ds_read_b64_tr_b16 v[90:91], v20 offset:4608
    s_add_u32 m0, s30, 24576
    s_add_u32 s28, s32, 5507072
    v_mfma_f32_16x16x32_bf16 v[152:155], v[48:51], v[32:35], v[152:155]
    ds_read_b64_tr_b16 v[92:93], v21 offset:4096
    v_mfma_f32_16x16x32_bf16 v[160:163], v[48:51], v[36:39], v[160:163]
    ds_read_b64_tr_b16 v[94:95], v21 offset:4608
    buffer_load_dwordx4 v11, s[8:11], s28 offen lds
    v_mfma_f32_16x16x32_bf16 v[140:143], v[52:55], v[24:27], v[140:143]
    s_waitcnt lgkmcnt(8)
    ds_read_b64_tr_b16 v[96:97], v22 offset:4096
    v_mfma_f32_16x16x32_bf16 v[148:151], v[52:55], v[28:31], v[148:151]
    ds_read_b64_tr_b16 v[98:99], v22 offset:4608
    v_mfma_f32_16x16x32_bf16 v[156:159], v[52:55], v[32:35], v[156:159]
    ds_read_b64_tr_b16 v[100:101], v23 offset:4096
    v_mfma_f32_16x16x32_bf16 v[164:167], v[52:55], v[36:39], v[164:167]
    ds_read_b64_tr_b16 v[102:103], v23 offset:4608
    v_mfma_f32_16x16x32_bf16 v[168:171], v[24:27], v[56:59], v[168:171]
    s_add_u32 s33, s34, 90112
    s_cmp_ge_u32 s33, 163840
    s_cselect_b32 s29, 163840, 0
    s_sub_u32 s33, s33, s29
    v_add_u32 v16, s33, v12
    v_mfma_f32_16x16x32_bf16 v[176:179], v[28:31], v[56:59], v[176:179]
    v_add_u32 v17, s33, v13
    v_mfma_f32_16x16x32_bf16 v[184:187], v[32:35], v[56:59], v[184:187]
    v_add_u32 v18, 122880, v14
    v_mfma_f32_16x16x32_bf16 v[192:195], v[36:39], v[56:59], v[192:195]
    v_add_u32 v19, 122880, v15
    v_mfma_f32_16x16x32_bf16 v[172:175], v[24:27], v[60:63], v[172:175]
    v_add_u32 v20, 131072, v14
    v_mfma_f32_16x16x32_bf16 v[180:183], v[28:31], v[60:63], v[180:183]
    v_add_u32 v21, 131072, v15
    v_mfma_f32_16x16x32_bf16 v[188:191], v[32:35], v[60:63], v[188:191]
    v_add_u32 v22, 139264, v14
    v_mfma_f32_16x16x32_bf16 v[196:199], v[36:39], v[60:63], v[196:199]
    v_add_u32 v23, 139264, v15
    s_waitcnt vmcnt(6) lgkmcnt(0)
    s_barrier
    v_mfma_f32_16x16x32_bf16 v[104:107], v[80:83], v[64:67], v[104:107]
    ds_read_b128 v[24:27], v16 offset:0
    v_mfma_f32_16x16x32_bf16 v[112:115], v[80:83], v[68:71], v[112:115]
    ds_read_b128 v[28:31], v16 offset:2048
    v_mfma_f32_16x16x32_bf16 v[120:123], v[80:83], v[72:75], v[120:123]
    ds_read_b128 v[32:35], v16 offset:4096
    v_mfma_f32_16x16x32_bf16 v[128:131], v[80:83], v[76:79], v[128:131]
    ds_read_b128 v[36:39], v16 offset:6144
    v_mfma_f32_16x16x32_bf16 v[108:111], v[84:87], v[64:67], v[108:111]
    ds_read_b64_tr_b16 v[40:41], v18 offset:0
    v_mfma_f32_16x16x32_bf16 v[116:119], v[84:87], v[68:71], v[116:119]
    ds_read_b64_tr_b16 v[42:43], v18 offset:512
    v_mfma_f32_16x16x32_bf16 v[124:127], v[84:87], v[72:75], v[124:127]
    ds_read_b64_tr_b16 v[44:45], v19 offset:0
    v_mfma_f32_16x16x32_bf16 v[132:135], v[84:87], v[76:79], v[132:135]
    ds_read_b64_tr_b16 v[46:47], v19 offset:512
    v_mfma_f32_16x16x32_bf16 v[136:139], v[88:91], v[64:67], v[136:139]
    ds_read_b64_tr_b16 v[48:49], v20 offset:0
    v_mfma_f32_16x16x32_bf16 v[144:147], v[88:91], v[68:71], v[144:147]
    ds_read_b64_tr_b16 v[50:51], v20 offset:512
    v_mfma_f32_16x16x32_bf16 v[152:155], v[88:91], v[72:75], v[152:155]
    ds_read_b64_tr_b16 v[52:53], v21 offset:0
    v_mfma_f32_16x16x32_bf16 v[160:163], v[88:91], v[76:79], v[160:163]
    ds_read_b64_tr_b16 v[54:55], v21 offset:512
    v_mfma_f32_16x16x32_bf16 v[140:143], v[92:95], v[64:67], v[140:143]
    s_waitcnt lgkmcnt(8)
    ds_read_b64_tr_b16 v[56:57], v22 offset:0
    v_mfma_f32_16x16x32_bf16 v[148:151], v[92:95], v[68:71], v[148:151]
    ds_read_b64_tr_b16 v[58:59], v22 offset:512
    v_mfma_f32_16x16x32_bf16 v[156:159], v[92:95], v[72:75], v[156:159]
    ds_read_b64_tr_b16 v[60:61], v23 offset:0
    v_mfma_f32_16x16x32_bf16 v[164:167], v[92:95], v[76:79], v[164:167]
    ds_read_b64_tr_b16 v[62:63], v23 offset:512
    v_mfma_f32_16x16x32_bf16 v[168:171], v[64:67], v[96:99], v[168:171]
    s_add_u32 m0, s30, 32768
    s_add_u32 s28, s32, 5509120
    v_mfma_f32_16x16x32_bf16 v[176:179], v[68:71], v[96:99], v[176:179]
    buffer_load_dwordx4 v11, s[8:11], s28 offen lds
    v_mfma_f32_16x16x32_bf16 v[184:187], v[72:75], v[96:99], v[184:187]
    s_add_u32 m0, s30, 40960
    s_add_u32 s28, s31, 1920
    v_mfma_f32_16x16x32_bf16 v[192:195], v[76:79], v[96:99], v[192:195]
    buffer_load_dwordx4 v10, s[4:7], s28 offen lds
    v_mfma_f32_16x16x32_bf16 v[172:175], v[64:67], v[100:103], v[172:175]
    s_add_u32 m0, s30, 49152
    s_add_u32 s28, s31, 132992
    v_mfma_f32_16x16x32_bf16 v[180:183], v[68:71], v[100:103], v[180:183]
    buffer_load_dwordx4 v10, s[4:7], s28 offen lds
    v_mfma_f32_16x16x32_bf16 v[188:191], v[72:75], v[100:103], v[188:191]
    s_add_u32 m0, s30, 57344
    s_add_u32 s28, s31, 264064
    v_mfma_f32_16x16x32_bf16 v[196:199], v[76:79], v[100:103], v[196:199]
    buffer_load_dwordx4 v10, s[4:7], s28 offen lds
    s_waitcnt lgkmcnt(0)
    v_mfma_f32_16x16x32_bf16 v[104:107], v[40:43], v[24:27], v[104:107]
    ds_read_b128 v[64:67], v17 offset:0
    v_mfma_f32_16x16x32_bf16 v[112:115], v[40:43], v[28:31], v[112:115]
    ds_read_b128 v[68:71], v17 offset:2048
    s_add_u32 m0, s30, 65536
    s_add_u32 s28, s31, 395136
    v_mfma_f32_16x16x32_bf16 v[120:123], v[40:43], v[32:35], v[120:123]
    ds_read_b128 v[72:75], v17 offset:4096
    v_mfma_f32_16x16x32_bf16 v[128:131], v[40:43], v[36:39], v[128:131]
    ds_read_b128 v[76:79], v17 offset:6144
    buffer_load_dwordx4 v10, s[4:7], s28 offen lds
    v_mfma_f32_16x16x32_bf16 v[108:111], v[44:47], v[24:27], v[108:111]
    ds_read_b64_tr_b16 v[80:81], v18 offset:4096
    v_mfma_f32_16x16x32_bf16 v[116:119], v[44:47], v[28:31], v[116:119]
    ds_read_b64_tr_b16 v[82:83], v18 offset:4608
    s_add_u32 m0, s30, 73728
    s_add_u32 s28, s32, 5898240
    v_mfma_f32_16x16x32_bf16 v[124:127], v[44:47], v[32:35], v[124:127]
    ds_read_b64_tr_b16 v[84:85], v19 offset:4096
    v_mfma_f32_16x16x32_bf16 v[132:135], v[44:47], v[36:39], v[132:135]
    ds_read_b64_tr_b16 v[86:87], v19 offset:4608
    buffer_load_dwordx4 v11, s[8:11], s28 offen lds
    v_mfma_f32_16x16x32_bf16 v[136:139], v[48:51], v[24:27], v[136:139]
    ds_read_b64_tr_b16 v[88:89], v20 offset:4096
    v_mfma_f32_16x16x32_bf16 v[144:147], v[48:51], v[28:31], v[144:147]
    ds_read_b64_tr_b16 v[90:91], v20 offset:4608
    s_add_u32 m0, s30, 81920
    s_add_u32 s28, s32, 5900288
    v_mfma_f32_16x16x32_bf16 v[152:155], v[48:51], v[32:35], v[152:155]
    ds_read_b64_tr_b16 v[92:93], v21 offset:4096
    v_mfma_f32_16x16x32_bf16 v[160:163], v[48:51], v[36:39], v[160:163]
    ds_read_b64_tr_b16 v[94:95], v21 offset:4608
    buffer_load_dwordx4 v11, s[8:11], s28 offen lds
    v_mfma_f32_16x16x32_bf16 v[140:143], v[52:55], v[24:27], v[140:143]
    s_waitcnt lgkmcnt(8)
    ds_read_b64_tr_b16 v[96:97], v22 offset:4096
    v_mfma_f32_16x16x32_bf16 v[148:151], v[52:55], v[28:31], v[148:151]
    ds_read_b64_tr_b16 v[98:99], v22 offset:4608
    v_mfma_f32_16x16x32_bf16 v[156:159], v[52:55], v[32:35], v[156:159]
    ds_read_b64_tr_b16 v[100:101], v23 offset:4096
    v_mfma_f32_16x16x32_bf16 v[164:167], v[52:55], v[36:39], v[164:167]
    ds_read_b64_tr_b16 v[102:103], v23 offset:4608
    v_mfma_f32_16x16x32_bf16 v[168:171], v[24:27], v[56:59], v[168:171]
    s_add_u32 s33, s34, 147456
    s_cmp_ge_u32 s33, 163840
    s_cselect_b32 s29, 163840, 0
    s_sub_u32 s33, s33, s29
    v_add_u32 v16, s33, v12
    v_mfma_f32_16x16x32_bf16 v[176:179], v[28:31], v[56:59], v[176:179]
    v_add_u32 v17, s33, v13
    v_mfma_f32_16x16x32_bf16 v[184:187], v[32:35], v[56:59], v[184:187]
    v_add_u32 v18, 16384, v14
    v_mfma_f32_16x16x32_bf16 v[192:195], v[36:39], v[56:59], v[192:195]
    v_add_u32 v19, 16384, v15
    v_mfma_f32_16x16x32_bf16 v[172:175], v[24:27], v[60:63], v[172:175]
    v_add_u32 v20, 24576, v14
    v_mfma_f32_16x16x32_bf16 v[180:183], v[28:31], v[60:63], v[180:183]
    v_add_u32 v21, 24576, v15
    v_mfma_f32_16x16x32_bf16 v[188:191], v[32:35], v[60:63], v[188:191]
    v_add_u32 v22, 32768, v14
    v_mfma_f32_16x16x32_bf16 v[196:199], v[36:39], v[60:63], v[196:199]
    v_add_u32 v23, 32768, v15
    s_waitcnt vmcnt(6) lgkmcnt(0)
    s_barrier
    v_mfma_f32_16x16x32_bf16 v[104:107], v[80:83], v[64:67], v[104:107]
    ds_read_b128 v[24:27], v16 offset:0
    v_mfma_f32_16x16x32_bf16 v[112:115], v[80:83], v[68:71], v[112:115]
    ds_read_b128 v[28:31], v16 offset:2048
    v_mfma_f32_16x16x32_bf16 v[120:123], v[80:83], v[72:75], v[120:123]
    ds_read_b128 v[32:35], v16 offset:4096
    v_mfma_f32_16x16x32_bf16 v[128:131], v[80:83], v[76:79], v[128:131]
    ds_read_b128 v[36:39], v16 offset:6144
    v_mfma_f32_16x16x32_bf16 v[108:111], v[84:87], v[64:67], v[108:111]
    ds_read_b64_tr_b16 v[40:41], v18 offset:0
    v_mfma_f32_16x16x32_bf16 v[116:119], v[84:87], v[68:71], v[116:119]
    ds_read_b64_tr_b16 v[42:43], v18 offset:512
    v_mfma_f32_16x16x32_bf16 v[124:127], v[84:87], v[72:75], v[124:127]
    ds_read_b64_tr_b16 v[44:45], v19 offset:0
    v_mfma_f32_16x16x32_bf16 v[132:135], v[84:87], v[76:79], v[132:135]
    ds_read_b64_tr_b16 v[46:47], v19 offset:512
    v_mfma_f32_16x16x32_bf16 v[136:139], v[88:91], v[64:67], v[136:139]
    ds_read_b64_tr_b16 v[48:49], v20 offset:0
    v_mfma_f32_16x16x32_bf16 v[144:147], v[88:91], v[68:71], v[144:147]
    ds_read_b64_tr_b16 v[50:51], v20 offset:512
    v_mfma_f32_16x16x32_bf16 v[152:155], v[88:91], v[72:75], v[152:155]
    ds_read_b64_tr_b16 v[52:53], v21 offset:0
    v_mfma_f32_16x16x32_bf16 v[160:163], v[88:91], v[76:79], v[160:163]
    ds_read_b64_tr_b16 v[54:55], v21 offset:512
    v_mfma_f32_16x16x32_bf16 v[140:143], v[92:95], v[64:67], v[140:143]
    s_waitcnt lgkmcnt(8)
    ds_read_b64_tr_b16 v[56:57], v22 offset:0
    v_mfma_f32_16x16x32_bf16 v[148:151], v[92:95], v[68:71], v[148:151]
    ds_read_b64_tr_b16 v[58:59], v22 offset:512
    v_mfma_f32_16x16x32_bf16 v[156:159], v[92:95], v[72:75], v[156:159]
    ds_read_b64_tr_b16 v[60:61], v23 offset:0
    v_mfma_f32_16x16x32_bf16 v[164:167], v[92:95], v[76:79], v[164:167]
    ds_read_b64_tr_b16 v[62:63], v23 offset:512
    v_mfma_f32_16x16x32_bf16 v[168:171], v[64:67], v[96:99], v[168:171]
    s_add_u32 m0, s30, 90112
    s_add_u32 s28, s32, 5902336
    v_mfma_f32_16x16x32_bf16 v[176:179], v[68:71], v[96:99], v[176:179]
    buffer_load_dwordx4 v11, s[8:11], s28 offen lds
    v_mfma_f32_16x16x32_bf16 v[184:187], v[72:75], v[96:99], v[184:187]
    v_mfma_f32_16x16x32_bf16 v[192:195], v[76:79], v[96:99], v[192:195]
    v_mfma_f32_16x16x32_bf16 v[172:175], v[64:67], v[100:103], v[172:175]
    v_mfma_f32_16x16x32_bf16 v[180:183], v[68:71], v[100:103], v[180:183]
    v_mfma_f32_16x16x32_bf16 v[188:191], v[72:75], v[100:103], v[188:191]
    v_mfma_f32_16x16x32_bf16 v[196:199], v[76:79], v[100:103], v[196:199]
    s_waitcnt lgkmcnt(0)
    v_mfma_f32_16x16x32_bf16 v[104:107], v[40:43], v[24:27], v[104:107]
    ds_read_b128 v[64:67], v17 offset:0
    v_mfma_f32_16x16x32_bf16 v[112:115], v[40:43], v[28:31], v[112:115]
    ds_read_b128 v[68:71], v17 offset:2048
    v_mfma_f32_16x16x32_bf16 v[120:123], v[40:43], v[32:35], v[120:123]
    ds_read_b128 v[72:75], v17 offset:4096
    v_mfma_f32_16x16x32_bf16 v[128:131], v[40:43], v[36:39], v[128:131]
    ds_read_b128 v[76:79], v17 offset:6144
    v_mfma_f32_16x16x32_bf16 v[108:111], v[44:47], v[24:27], v[108:111]
    ds_read_b64_tr_b16 v[80:81], v18 offset:4096
    v_mfma_f32_16x16x32_bf16 v[116:119], v[44:47], v[28:31], v[116:119]
    ds_read_b64_tr_b16 v[82:83], v18 offset:4608
    v_mfma_f32_16x16x32_bf16 v[124:127], v[44:47], v[32:35], v[124:127]
    ds_read_b64_tr_b16 v[84:85], v19 offset:4096
    v_mfma_f32_16x16x32_bf16 v[132:135], v[44:47], v[36:39], v[132:135]
    ds_read_b64_tr_b16 v[86:87], v19 offset:4608
    v_mfma_f32_16x16x32_bf16 v[136:139], v[48:51], v[24:27], v[136:139]
    ds_read_b64_tr_b16 v[88:89], v20 offset:4096
    v_mfma_f32_16x16x32_bf16 v[144:147], v[48:51], v[28:31], v[144:147]
    ds_read_b64_tr_b16 v[90:91], v20 offset:4608
    v_mfma_f32_16x16x32_bf16 v[152:155], v[48:51], v[32:35], v[152:155]
    ds_read_b64_tr_b16 v[92:93], v21 offset:4096
    v_mfma_f32_16x16x32_bf16 v[160:163], v[48:51], v[36:39], v[160:163]
    ds_read_b64_tr_b16 v[94:95], v21 offset:4608
    v_mfma_f32_16x16x32_bf16 v[140:143], v[52:55], v[24:27], v[140:143]
    s_waitcnt lgkmcnt(8)
    ds_read_b64_tr_b16 v[96:97], v22 offset:4096
    v_mfma_f32_16x16x32_bf16 v[148:151], v[52:55], v[28:31], v[148:151]
    ds_read_b64_tr_b16 v[98:99], v22 offset:4608
    v_mfma_f32_16x16x32_bf16 v[156:159], v[52:55], v[32:35], v[156:159]
    ds_read_b64_tr_b16 v[100:101], v23 offset:4096
    v_mfma_f32_16x16x32_bf16 v[164:167], v[52:55], v[36:39], v[164:167]
    ds_read_b64_tr_b16 v[102:103], v23 offset:4608
    v_mfma_f32_16x16x32_bf16 v[168:171], v[24:27], v[56:59], v[168:171]
    s_add_u32 s33, s34, 40960
    s_cmp_ge_u32 s33, 163840
    s_cselect_b32 s29, 163840, 0
    s_sub_u32 s33, s33, s29
    v_add_u32 v16, s33, v12
    v_mfma_f32_16x16x32_bf16 v[176:179], v[28:31], v[56:59], v[176:179]
    v_add_u32 v17, s33, v13
    v_mfma_f32_16x16x32_bf16 v[184:187], v[32:35], v[56:59], v[184:187]
    v_add_u32 v18, 73728, v14
    v_mfma_f32_16x16x32_bf16 v[192:195], v[36:39], v[56:59], v[192:195]
    v_add_u32 v19, 73728, v15
    v_mfma_f32_16x16x32_bf16 v[172:175], v[24:27], v[60:63], v[172:175]
    v_add_u32 v20, 81920, v14
    v_mfma_f32_16x16x32_bf16 v[180:183], v[28:31], v[60:63], v[180:183]
    v_add_u32 v21, 81920, v15
    v_mfma_f32_16x16x32_bf16 v[188:191], v[32:35], v[60:63], v[188:191]
    v_add_u32 v22, 90112, v14
    v_mfma_f32_16x16x32_bf16 v[196:199], v[36:39], v[60:63], v[196:199]
    v_add_u32 v23, 90112, v15
    s_waitcnt vmcnt(0) lgkmcnt(0)
    s_barrier
    v_mfma_f32_16x16x32_bf16 v[104:107], v[80:83], v[64:67], v[104:107]
    ds_read_b128 v[24:27], v16 offset:0
    v_mfma_f32_16x16x32_bf16 v[112:115], v[80:83], v[68:71], v[112:115]
    ds_read_b128 v[28:31], v16 offset:2048
    v_mfma_f32_16x16x32_bf16 v[120:123], v[80:83], v[72:75], v[120:123]
    ds_read_b128 v[32:35], v16 offset:4096
    v_mfma_f32_16x16x32_bf16 v[128:131], v[80:83], v[76:79], v[128:131]
    ds_read_b128 v[36:39], v16 offset:6144
    v_mfma_f32_16x16x32_bf16 v[108:111], v[84:87], v[64:67], v[108:111]
    ds_read_b64_tr_b16 v[40:41], v18 offset:0
    v_mfma_f32_16x16x32_bf16 v[116:119], v[84:87], v[68:71], v[116:119]
    ds_read_b64_tr_b16 v[42:43], v18 offset:512
    v_mfma_f32_16x16x32_bf16 v[124:127], v[84:87], v[72:75], v[124:127]
    ds_read_b64_tr_b16 v[44:45], v19 offset:0
    v_mfma_f32_16x16x32_bf16 v[132:135], v[84:87], v[76:79], v[132:135]
    ds_read_b64_tr_b16 v[46:47], v19 offset:512
    v_mfma_f32_16x16x32_bf16 v[136:139], v[88:91], v[64:67], v[136:139]
    ds_read_b64_tr_b16 v[48:49], v20 offset:0
    v_mfma_f32_16x16x32_bf16 v[144:147], v[88:91], v[68:71], v[144:147]
    ds_read_b64_tr_b16 v[50:51], v20 offset:512
    v_mfma_f32_16x16x32_bf16 v[152:155], v[88:91], v[72:75], v[152:155]
    ds_read_b64_tr_b16 v[52:53], v21 offset:0
    v_mfma_f32_16x16x32_bf16 v[160:163], v[88:91], v[76:79], v[160:163]
    ds_read_b64_tr_b16 v[54:55], v21 offset:512
    v_mfma_f32_16x16x32_bf16 v[140:143], v[92:95], v[64:67], v[140:143]
    s_waitcnt lgkmcnt(8)
    ds_read_b64_tr_b16 v[56:57], v22 offset:0
    v_mfma_f32_16x16x32_bf16 v[148:151], v[92:95], v[68:71], v[148:151]
    ds_read_b64_tr_b16 v[58:59], v22 offset:512
    v_mfma_f32_16x16x32_bf16 v[156:159], v[92:95], v[72:75], v[156:159]
    ds_read_b64_tr_b16 v[60:61], v23 offset:0
    v_mfma_f32_16x16x32_bf16 v[164:167], v[92:95], v[76:79], v[164:167]
    ds_read_b64_tr_b16 v[62:63], v23 offset:512
    v_mfma_f32_16x16x32_bf16 v[168:171], v[64:67], v[96:99], v[168:171]
    v_mfma_f32_16x16x32_bf16 v[176:179], v[68:71], v[96:99], v[176:179]
    v_mfma_f32_16x16x32_bf16 v[184:187], v[72:75], v[96:99], v[184:187]
    v_mfma_f32_16x16x32_bf16 v[192:195], v[76:79], v[96:99], v[192:195]
    v_mfma_f32_16x16x32_bf16 v[172:175], v[64:67], v[100:103], v[172:175]
    v_mfma_f32_16x16x32_bf16 v[180:183], v[68:71], v[100:103], v[180:183]
    v_mfma_f32_16x16x32_bf16 v[188:191], v[72:75], v[100:103], v[188:191]
    v_mfma_f32_16x16x32_bf16 v[196:199], v[76:79], v[100:103], v[196:199]
    s_waitcnt lgkmcnt(0)
    v_mfma_f32_16x16x32_bf16 v[104:107], v[40:43], v[24:27], v[104:107]
    ds_read_b128 v[64:67], v17 offset:0
    v_mfma_f32_16x16x32_bf16 v[112:115], v[40:43], v[28:31], v[112:115]
    ds_read_b128 v[68:71], v17 offset:2048
    v_mfma_f32_16x16x32_bf16 v[120:123], v[40:43], v[32:35], v[120:123]
    ds_read_b128 v[72:75], v17 offset:4096
    v_mfma_f32_16x16x32_bf16 v[128:131], v[40:43], v[36:39], v[128:131]
    ds_read_b128 v[76:79], v17 offset:6144
    v_mfma_f32_16x16x32_bf16 v[108:111], v[44:47], v[24:27], v[108:111]
    ds_read_b64_tr_b16 v[80:81], v18 offset:4096
    v_mfma_f32_16x16x32_bf16 v[116:119], v[44:47], v[28:31], v[116:119]
    ds_read_b64_tr_b16 v[82:83], v18 offset:4608
    v_mfma_f32_16x16x32_bf16 v[124:127], v[44:47], v[32:35], v[124:127]
    ds_read_b64_tr_b16 v[84:85], v19 offset:4096
    v_mfma_f32_16x16x32_bf16 v[132:135], v[44:47], v[36:39], v[132:135]
    ds_read_b64_tr_b16 v[86:87], v19 offset:4608
    v_mfma_f32_16x16x32_bf16 v[136:139], v[48:51], v[24:27], v[136:139]
    ds_read_b64_tr_b16 v[88:89], v20 offset:4096
    v_mfma_f32_16x16x32_bf16 v[144:147], v[48:51], v[28:31], v[144:147]
    ds_read_b64_tr_b16 v[90:91], v20 offset:4608
    v_mfma_f32_16x16x32_bf16 v[152:155], v[48:51], v[32:35], v[152:155]
    ds_read_b64_tr_b16 v[92:93], v21 offset:4096
    v_mfma_f32_16x16x32_bf16 v[160:163], v[48:51], v[36:39], v[160:163]
    ds_read_b64_tr_b16 v[94:95], v21 offset:4608
    v_mfma_f32_16x16x32_bf16 v[140:143], v[52:55], v[24:27], v[140:143]
    s_waitcnt lgkmcnt(8)
    ds_read_b64_tr_b16 v[96:97], v22 offset:4096
    v_mfma_f32_16x16x32_bf16 v[148:151], v[52:55], v[28:31], v[148:151]
    ds_read_b64_tr_b16 v[98:99], v22 offset:4608
    v_mfma_f32_16x16x32_bf16 v[156:159], v[52:55], v[32:35], v[156:159]
    ds_read_b64_tr_b16 v[100:101], v23 offset:4096
    v_mfma_f32_16x16x32_bf16 v[164:167], v[52:55], v[36:39], v[164:167]
    ds_read_b64_tr_b16 v[102:103], v23 offset:4608
    v_mfma_f32_16x16x32_bf16 v[168:171], v[24:27], v[56:59], v[168:171]
    v_mfma_f32_16x16x32_bf16 v[176:179], v[28:31], v[56:59], v[176:179]
    v_mfma_f32_16x16x32_bf16 v[184:187], v[32:35], v[56:59], v[184:187]
    v_mfma_f32_16x16x32_bf16 v[192:195], v[36:39], v[56:59], v[192:195]
    v_mfma_f32_16x16x32_bf16 v[172:175], v[24:27], v[60:63], v[172:175]
    v_mfma_f32_16x16x32_bf16 v[180:183], v[28:31], v[60:63], v[180:183]
    v_mfma_f32_16x16x32_bf16 v[188:191], v[32:35], v[60:63], v[188:191]
    v_mfma_f32_16x16x32_bf16 v[196:199], v[36:39], v[60:63], v[196:199]
    s_waitcnt lgkmcnt(0)
    s_cmp_eq_u32 s20, 0
    s_cbranch_scc0 gated_mix__mha_block__softmax_full_mha__prompt_kernel_chk0
    s_waitcnt vmcnt(0)
    s_mov_b32 s18, 6000
gated_mix__mha_block__softmax_full_mha__prompt_kernel_spin0_l:
    v_readfirstlane_b32 s28, v244
    s_nop 0
    s_cmp_ge_u32 s28, 64
    s_cbranch_scc1 gated_mix__mha_block__softmax_full_mha__prompt_kernel_spin0_ok
gated_mix__mha_block__softmax_full_mha__prompt_kernel_spin0_re:
    s_sub_u32 s18, s18, 1
    s_cmp_eq_u32 s18, 0
    s_cbranch_scc1 gated_mix__mha_block__softmax_full_mha__prompt_kernel_spin0_ok
    buffer_load_dword v244, v243, s[36:39], 0 offen sc1
    s_waitcnt vmcnt(0)
    s_branch gated_mix__mha_block__softmax_full_mha__prompt_kernel_spin0_l
gated_mix__mha_block__softmax_full_mha__prompt_kernel_spin0_ok:
gated_mix__mha_block__softmax_full_mha__prompt_kernel_chk0:
    s_barrier
    v_mfma_f32_16x16x32_bf16 v[104:107], v[80:83], v[64:67], v[104:107]
    v_mfma_f32_16x16x32_bf16 v[112:115], v[80:83], v[68:71], v[112:115]
    v_mfma_f32_16x16x32_bf16 v[120:123], v[80:83], v[72:75], v[120:123]
    v_mfma_f32_16x16x32_bf16 v[128:131], v[80:83], v[76:79], v[128:131]
    v_mfma_f32_16x16x32_bf16 v[108:111], v[84:87], v[64:67], v[108:111]
    v_mfma_f32_16x16x32_bf16 v[116:119], v[84:87], v[68:71], v[116:119]
    v_mfma_f32_16x16x32_bf16 v[124:127], v[84:87], v[72:75], v[124:127]
    v_mfma_f32_16x16x32_bf16 v[132:135], v[84:87], v[76:79], v[132:135]
    v_mfma_f32_16x16x32_bf16 v[136:139], v[88:91], v[64:67], v[136:139]
    v_mfma_f32_16x16x32_bf16 v[144:147], v[88:91], v[68:71], v[144:147]
    v_mfma_f32_16x16x32_bf16 v[152:155], v[88:91], v[72:75], v[152:155]
    v_mfma_f32_16x16x32_bf16 v[160:163], v[88:91], v[76:79], v[160:163]
    v_mfma_f32_16x16x32_bf16 v[140:143], v[92:95], v[64:67], v[140:143]
    v_mfma_f32_16x16x32_bf16 v[148:151], v[92:95], v[68:71], v[148:151]
    v_mfma_f32_16x16x32_bf16 v[156:159], v[92:95], v[72:75], v[156:159]
    v_mfma_f32_16x16x32_bf16 v[164:167], v[92:95], v[76:79], v[164:167]
    v_mfma_f32_16x16x32_bf16 v[168:171], v[64:67], v[96:99], v[168:171]
    v_mfma_f32_16x16x32_bf16 v[176:179], v[68:71], v[96:99], v[176:179]
    v_mfma_f32_16x16x32_bf16 v[184:187], v[72:75], v[96:99], v[184:187]
    v_mfma_f32_16x16x32_bf16 v[192:195], v[76:79], v[96:99], v[192:195]
    v_mfma_f32_16x16x32_bf16 v[172:175], v[64:67], v[100:103], v[172:175]
    v_mfma_f32_16x16x32_bf16 v[180:183], v[68:71], v[100:103], v[180:183]
    v_mfma_f32_16x16x32_bf16 v[188:191], v[72:75], v[100:103], v[188:191]
    v_mfma_f32_16x16x32_bf16 v[196:199], v[76:79], v[100:103], v[196:199]
    v_mov_b32 v3, s35
    v_add_u32 v3, 33554432, v3
    v_cmp_eq_u32 vcc, 63, v1
    s_and_saveexec_b64 s[16:17], vcc
    buffer_store_dword v9, v3, s[12:15], 0 offen sc1
    s_mov_b64 exec, s[16:17]
    s_lshl_b32 s28, s21, 14
    s_lshl_b32 s29, s22, 13
    s_add_u32 s28, s28, s29
    v_add_u32 v6, s28, v248
    v_add_u32 v7, s28, v249
    s_nop 3
    v_cvt_pk_bf16_f32 v208, v136, v137
    v_cvt_pk_bf16_f32 v209, v138, v139
    v_cvt_pk_bf16_f32 v210, v140, v141
    v_cvt_pk_bf16_f32 v211, v142, v143
    v_cvt_pk_bf16_f32 v212, v144, v145
    v_cvt_pk_bf16_f32 v213, v146, v147
    v_cvt_pk_bf16_f32 v214, v148, v149
    v_cvt_pk_bf16_f32 v215, v150, v151
    v_cvt_pk_bf16_f32 v216, v168, v169
    v_cvt_pk_bf16_f32 v217, v170, v171
    v_cvt_pk_bf16_f32 v218, v176, v177
    v_cvt_pk_bf16_f32 v219, v178, v179
    v_cvt_pk_bf16_f32 v220, v172, v173
    v_cvt_pk_bf16_f32 v221, v174, v175
    v_cvt_pk_bf16_f32 v222, v180, v181
    v_cvt_pk_bf16_f32 v223, v182, v183
    v_cvt_pk_bf16_f32 v224, v152, v153
    v_cvt_pk_bf16_f32 v225, v154, v155
    v_cvt_pk_bf16_f32 v226, v156, v157
    v_cvt_pk_bf16_f32 v227, v158, v159
    v_cvt_pk_bf16_f32 v228, v160, v161
    v_cvt_pk_bf16_f32 v229, v162, v163
    v_cvt_pk_bf16_f32 v230, v164, v165
    v_cvt_pk_bf16_f32 v231, v166, v167
    v_cvt_pk_bf16_f32 v232, v184, v185
    v_cvt_pk_bf16_f32 v233, v186, v187
    v_cvt_pk_bf16_f32 v234, v192, v193
    v_cvt_pk_bf16_f32 v235, v194, v195
    v_cvt_pk_bf16_f32 v236, v188, v189
    v_cvt_pk_bf16_f32 v237, v190, v191
    v_cvt_pk_bf16_f32 v238, v196, v197
    v_cvt_pk_bf16_f32 v239, v198, v199
    ds_write_b128 v6, v[208:211] offset:0
    ds_write_b128 v6, v[212:215] offset:128
    ds_write_b128 v7, v[216:219] offset:2048
    ds_write_b128 v7, v[220:223] offset:2304
    ds_write_b128 v6, v[224:227] offset:4096
    ds_write_b128 v6, v[228:231] offset:4224
    ds_write_b128 v7, v[232:235] offset:6144
    ds_write_b128 v7, v[236:239] offset:6400
    s_cmp_eq_u32 s21, 0
    s_cbranch_scc0 gated_mix__mha_block__softmax_full_mha__prompt_kernel_st0
    s_add_u32 s29, s100, 0
    buffer_store_dwordx4 v[208:211], v248, s[12:15], s29 offen offset:0 sc1
    buffer_store_dwordx4 v[212:215], v248, s[12:15], s29 offen offset:128 sc1
    buffer_store_dwordx4 v[216:219], v249, s[12:15], s29 offen offset:2048 sc1
    buffer_store_dwordx4 v[220:223], v249, s[12:15], s29 offen offset:2304 sc1
    s_add_u32 s29, s100, 4096
    buffer_store_dwordx4 v[224:227], v248, s[12:15], s29 offen offset:0 sc1
    buffer_store_dwordx4 v[228:231], v248, s[12:15], s29 offen offset:128 sc1
    buffer_store_dwordx4 v[232:235], v249, s[12:15], s29 offen offset:2048 sc1
    buffer_store_dwordx4 v[236:239], v249, s[12:15], s29 offen offset:2304 sc1
gated_mix__mha_block__softmax_full_mha__prompt_kernel_st0:
    s_mov_b32 s28, 0x3e8293ee
    s_mov_b32 s29, 0x3e8293ee
    v_pk_mul_f32 v[104:105], v[104:105], s[28:29]
    v_pk_mul_f32 v[106:107], v[106:107], s[28:29]
    v_cvt_pk_bf16_f32 v8, v104, v105
    v_cvt_pk_bf16_f32 v9, v106, v107
    v_pk_mul_f32 v[108:109], v[108:109], s[28:29]
    v_pk_mul_f32 v[110:111], v[110:111], s[28:29]
    v_cvt_pk_bf16_f32 v10, v108, v109
    v_cvt_pk_bf16_f32 v11, v110, v111
    v_pk_mul_f32 v[112:113], v[112:113], s[28:29]
    v_pk_mul_f32 v[114:115], v[114:115], s[28:29]
    v_cvt_pk_bf16_f32 v12, v112, v113
    v_cvt_pk_bf16_f32 v13, v114, v115
    v_pk_mul_f32 v[116:117], v[116:117], s[28:29]
    v_pk_mul_f32 v[118:119], v[118:119], s[28:29]
    v_cvt_pk_bf16_f32 v14, v116, v117
    v_cvt_pk_bf16_f32 v15, v118, v119
    s_nop 1
    v_permlane16_swap_b32 v8, v12
    v_permlane16_swap_b32 v9, v13
    v_permlane16_swap_b32 v10, v14
    v_permlane16_swap_b32 v11, v15
    s_nop 1
    v_permlane32_swap_b32 v8, v12
    v_permlane32_swap_b32 v9, v13
    v_permlane32_swap_b32 v10, v14
    v_permlane32_swap_b32 v11, v15
    v_pk_mul_f32 v[120:121], v[120:121], s[28:29]
    v_pk_mul_f32 v[122:123], v[122:123], s[28:29]
    v_cvt_pk_bf16_f32 v16, v120, v121
    v_cvt_pk_bf16_f32 v17, v122, v123
    v_pk_mul_f32 v[124:125], v[124:125], s[28:29]
    v_pk_mul_f32 v[126:127], v[126:127], s[28:29]
    v_cvt_pk_bf16_f32 v18, v124, v125
    v_cvt_pk_bf16_f32 v19, v126, v127
    v_pk_mul_f32 v[128:129], v[128:129], s[28:29]
    v_pk_mul_f32 v[130:131], v[130:131], s[28:29]
    v_cvt_pk_bf16_f32 v20, v128, v129
    v_cvt_pk_bf16_f32 v21, v130, v131
    v_pk_mul_f32 v[132:133], v[132:133], s[28:29]
    v_pk_mul_f32 v[134:135], v[134:135], s[28:29]
    v_cvt_pk_bf16_f32 v22, v132, v133
    v_cvt_pk_bf16_f32 v23, v134, v135
    s_nop 1
    v_permlane16_swap_b32 v16, v20
    v_permlane16_swap_b32 v17, v21
    v_permlane16_swap_b32 v18, v22
    v_permlane16_swap_b32 v19, v23
    s_nop 1
    v_permlane32_swap_b32 v16, v20
    v_permlane32_swap_b32 v17, v21
    v_permlane32_swap_b32 v18, v22
    v_permlane32_swap_b32 v19, v23
    s_cmp_eq_u32 s22, 0
    s_cselect_b32 s4, s44, s50
    s_cselect_b32 s5, s45, s51
    s_mov_b32 s6, 2097152
    s_mov_b32 s7, 0x20000
    s_mov_b32 s8, s54
    s_mov_b32 s9, s55
    s_mov_b32 s10, 4194304
    s_mov_b32 s11, 0x20000
    v_mov_b32 v72, 0
    v_mov_b32 v73, 0
    v_mov_b32 v74, 0
    v_mov_b32 v75, 0
    v_mov_b32 v76, 0
    v_mov_b32 v77, 0
    v_mov_b32 v78, 0
    v_mov_b32 v79, 0
    s_waitcnt lgkmcnt(0)
    s_barrier
    ds_read_b128 v[24:27], v251 offset:0
    ds_read_b128 v[28:31], v251 offset:1024
    s_waitcnt lgkmcnt(0)
    v_mfma_f32_32x32x16_bf16 v[96:111], v[24:27], v[8:11], 0
    v_mfma_f32_32x32x16_bf16 v[96:111], v[28:31], v[12:15], v[96:111]
    v_mfma_f32_32x32x16_bf16 v[112:127], v[24:27], v[16:19], 0
    v_mfma_f32_32x32x16_bf16 v[112:127], v[28:31], v[20:23], v[112:127]
    s_nop 7
    s_nop 3
    v_max3_f32 v192, v96, v97, v98
    v_max3_f32 v192, v192, v99, v100
    v_max3_f32 v192, v192, v101, v102
    v_max3_f32 v192, v192, v103, v104
    v_max3_f32 v192, v192, v105, v106
    v_max3_f32 v192, v192, v107, v108
    v_max3_f32 v192, v192, v109, v110
    v_max_f32 v192, v192, v111
    v_mov_b32 v193, v192
    s_nop 1
    v_permlane32_swap_b32 v192, v193
    s_nop 0
    v_max_f32 v192, v192, v193
    v_sub_f32 v160, 0, v192
    v_sub_f32 v161, 0, v192
    v_sub_f32 v162, 0, v192
    v_sub_f32 v163, 0, v192
    v_sub_f32 v164, 0, v192
    v_sub_f32 v165, 0, v192
    v_sub_f32 v166, 0, v192
    v_sub_f32 v167, 0, v192
    v_sub_f32 v168, 0, v192
    v_sub_f32 v169, 0, v192
    v_sub_f32 v170, 0, v192
    v_sub_f32 v171, 0, v192
    v_sub_f32 v172, 0, v192
    v_sub_f32 v173, 0, v192
    v_sub_f32 v174, 0, v192
    v_sub_f32 v175, 0, v192
    v_max3_f32 v192, v112, v113, v114
    v_max3_f32 v192, v192, v115, v116
    v_max3_f32 v192, v192, v117, v118
    v_max3_f32 v192, v192, v119, v120
    v_max3_f32 v192, v192, v121, v122
    v_max3_f32 v192, v192, v123, v124
    v_max3_f32 v192, v192, v125, v126
    v_max_f32 v192, v192, v127
    v_mov_b32 v193, v192
    s_nop 1
    v_permlane32_swap_b32 v192, v193
    s_nop 0
    v_max_f32 v192, v192, v193
    v_sub_f32 v176, 0, v192
    v_sub_f32 v177, 0, v192
    v_sub_f32 v178, 0, v192
    v_sub_f32 v179, 0, v192
    v_sub_f32 v180, 0, v192
    v_sub_f32 v181, 0, v192
    v_sub_f32 v182, 0, v192
    v_sub_f32 v183, 0, v192
    v_sub_f32 v184, 0, v192
    v_sub_f32 v185, 0, v192
    v_sub_f32 v186, 0, v192
    v_sub_f32 v187, 0, v192
    v_sub_f32 v188, 0, v192
    v_sub_f32 v189, 0, v192
    v_sub_f32 v190, 0, v192
    v_sub_f32 v191, 0, v192
    s_lshl_b32 s28, s23, 8
    s_add_u32 s28, s28, 34603008
    v_and_b32 v92, 31, v1
    v_lshl_add_u32 v92, v92, 2, s28
    s_add_u32 s35, s24, 1
    s_and_b32 s35, s35, 7
    s_lshl_b32 s35, s35, 2
    v_mfma_f32_32x32x16_bf16 v[96:111], v[24:27], v[8:11], v[160:175]
    ds_read_b128 v[32:35], v251 offset:4096
    v_mfma_f32_32x32x16_bf16 v[96:111], v[28:31], v[12:15], v[96:111]
    ds_read_b128 v[36:39], v251 offset:5120
    ds_read_b128 v[40:43], v251 offset:2048
    ds_read_b128 v[44:47], v251 offset:3072
    s_nop 7
    s_nop 3
    v_exp_f32 v96, v96
    v_exp_f32 v97, v97
    v_exp_f32 v98, v98
    v_mfma_f32_32x32x16_bf16 v[112:127], v[24:27], v[16:19], v[176:191]
    s_cmp_eq_u32 s21, 1
    s_cbranch_scc0 gated_mix__mha_block__softmax_full_mha__prompt_kernel_st1
    s_add_u32 s29, s100, 0
    buffer_store_dwordx4 v[208:211], v248, s[12:15], s29 offen offset:0 sc1
    buffer_store_dwordx4 v[212:215], v248, s[12:15], s29 offen offset:128 sc1
    buffer_store_dwordx4 v[216:219], v249, s[12:15], s29 offen offset:2048 sc1
    buffer_store_dwordx4 v[220:223], v249, s[12:15], s29 offen offset:2304 sc1
    s_add_u32 s29, s100, 4096
    buffer_store_dwordx4 v[224:227], v248, s[12:15], s29 offen offset:0 sc1
    buffer_store_dwordx4 v[228:231], v248, s[12:15], s29 offen offset:128 sc1
    buffer_store_dwordx4 v[232:235], v249, s[12:15], s29 offen offset:2048 sc1
    buffer_store_dwordx4 v[236:239], v249, s[12:15], s29 offen offset:2304 sc1
gated_mix__mha_block__softmax_full_mha__prompt_kernel_st1:
    v_exp_f32 v99, v99
    v_cvt_pk_bf16_f32 v56, v96, v97
    v_exp_f32 v100, v100
    v_exp_f32 v101, v101
    v_cvt_pk_bf16_f32 v57, v98, v99
    v_mfma_f32_32x32x16_bf16 v[112:127], v[28:31], v[20:23], v[112:127]
    v_exp_f32 v102, v102
    v_exp_f32 v103, v103
    v_cvt_pk_bf16_f32 v58, v100, v101
    v_exp_f32 v104, v104
    v_exp_f32 v105, v105
    v_cvt_pk_bf16_f32 v59, v102, v103
    v_exp_f32 v106, v106
    v_exp_f32 v107, v107
    v_cvt_pk_bf16_f32 v60, v104, v105
    v_exp_f32 v108, v108
    v_exp_f32 v109, v109
    v_cvt_pk_bf16_f32 v61, v106, v107
    v_exp_f32 v110, v110
    v_exp_f32 v111, v111
    v_cvt_pk_bf16_f32 v62, v108, v109
    v_cvt_pk_bf16_f32 v63, v110, v111
    s_waitcnt lgkmcnt(0)
    s_cmp_eq_u32 s21, 0
    s_cbranch_scc0 gated_mix__mha_block__softmax_full_mha__prompt_kernel_sg0
    s_waitcnt vmcnt(0)
    v_mov_b32 v3, 1
    v_cmp_gt_u32 vcc, 1, v1
    s_and_saveexec_b64 s[16:17], vcc
    buffer_atomic_add v3, v242, s[12:15], 0 offen offset:0 sc1
    s_mov_b64 exec, s[16:17]
gated_mix__mha_block__softmax_full_mha__prompt_kernel_sg0:
    v_exp_f32 v112, v112
    v_exp_f32 v113, v113
    v_exp_f32 v114, v114
    v_mfma_f32_32x32x16_bf16 v[96:111], v[32:35], v[8:11], v[160:175]
    ds_read_b128 v[24:27], v251 offset:16384
    v_exp_f32 v115, v115
    v_cvt_pk_bf16_f32 v64, v112, v113
    v_exp_f32 v116, v116
    v_exp_f32 v117, v117
    v_cvt_pk_bf16_f32 v65, v114, v115
    v_mfma_f32_32x32x16_bf16 v[96:111], v[36:39], v[12:15], v[96:111]
    ds_read_b128 v[28:31], v251 offset:17408
    v_exp_f32 v118, v118
    v_exp_f32 v119, v119
    v_cvt_pk_bf16_f32 v66, v116, v117
    v_exp_f32 v120, v120
    v_exp_f32 v121, v121
    v_cvt_pk_bf16_f32 v67, v118, v119
    v_mfma_f32_32x32x16_bf16 v[128:143], v[40:43], v[56:59], 0
    ds_read_b128 v[48:51], v251 offset:6144
    v_exp_f32 v122, v122
    v_exp_f32 v123, v123
    v_cvt_pk_bf16_f32 v68, v120, v121
    v_exp_f32 v124, v124
    v_exp_f32 v125, v125
    v_cvt_pk_bf16_f32 v69, v122, v123
    v_smfmac_f32_16x16x64_bf16 v[72:75], v[252:255], v[56:63], v250
    ds_read_b128 v[52:55], v251 offset:7168
    v_exp_f32 v126, v126
    v_exp_f32 v127, v127
    v_cvt_pk_bf16_f32 v70, v124, v125
    v_mfma_f32_32x32x16_bf16 v[128:143], v[44:47], v[60:63], v[128:143]
    v_cvt_pk_bf16_f32 v71, v126, v127
    v_exp_f32 v96, v96
    v_exp_f32 v97, v97
    v_exp_f32 v98, v98
    v_mfma_f32_32x32x16_bf16 v[112:127], v[32:35], v[16:19], v[176:191]
    s_waitcnt lgkmcnt(0)
    v_exp_f32 v99, v99
    v_cvt_pk_bf16_f32 v56, v96, v97
    v_exp_f32 v100, v100
    v_exp_f32 v101, v101
    v_cvt_pk_bf16_f32 v57, v98, v99
    v_mfma_f32_32x32x16_bf16 v[112:127], v[36:39], v[20:23], v[112:127]
    v_exp_f32 v102, v102
    v_exp_f32 v103, v103
    v_cvt_pk_bf16_f32 v58, v100, v101
    v_exp_f32 v104, v104
    v_exp_f32 v105, v105
    v_cvt_pk_bf16_f32 v59, v102, v103
    v_mfma_f32_32x32x16_bf16 v[144:159], v[40:43], v[64:67], 0
    v_exp_f32 v106, v106
    v_exp_f32 v107, v107
    v_cvt_pk_bf16_f32 v60, v104, v105
    v_exp_f32 v108, v108
    v_exp_f32 v109, v109
    v_cvt_pk_bf16_f32 v61, v106, v107
    v_smfmac_f32_16x16x64_bf16 v[76:79], v[252:255], v[64:71], v250
    v_exp_f32 v110, v110
    v_exp_f32 v111, v111
    v_cvt_pk_bf16_f32 v62, v108, v109
    v_mfma_f32_32x32x16_bf16 v[144:159], v[44:47], v[68:71], v[144:159]
    v_cvt_pk_bf16_f32 v63, v110, v111
    v_exp_f32 v112, v112
    v_exp_f32 v113, v113
    v_exp_f32 v114, v114
    v_mfma_f32_32x32x16_bf16 v[96:111], v[24:27], v[8:11], v[160:175]
    ds_read_b128 v[32:35], v251 offset:20480
    v_exp_f32 v115, v115
    v_cvt_pk_bf16_f32 v64, v112, v113
    v_exp_f32 v116, v116
    v_exp_f32 v117, v117
    v_cvt_pk_bf16_f32 v65, v114, v115
    v_mfma_f32_32x32x16_bf16 v[96:111], v[28:31], v[12:15], v[96:111]
    ds_read_b128 v[36:39], v251 offset:21504
    v_exp_f32 v118, v118
    v_exp_f32 v119, v119
    v_cvt_pk_bf16_f32 v66, v116, v117
    v_exp_f32 v120, v120
    v_exp_f32 v121, v121
    v_cvt_pk_bf16_f32 v67, v118, v119
    v_mfma_f32_32x32x16_bf16 v[128:143], v[48:51], v[56:59], v[128:143]
    ds_read_b128 v[40:43], v251 offset:18432
    v_exp_f32 v122, v122
    v_exp_f32 v123, v123
    v_cvt_pk_bf16_f32 v68, v120, v121
    v_exp_f32 v124, v124
    v_exp_f32 v125, v125
    v_cvt_pk_bf16_f32 v69, v122, v123
    v_smfmac_f32_16x16x64_bf16 v[72:75], v[252:255], v[56:63], v250
    ds_read_b128 v[44:47], v251 offset:19456
    v_exp_f32 v126, v126
    v_exp_f32 v127, v127
    v_cvt_pk_bf16_f32 v70, v124, v125
    v_mfma_f32_32x32x16_bf16 v[128:143], v[52:55], v[60:63], v[128:143]
    v_cvt_pk_bf16_f32 v71, v126, v127
    v_exp_f32 v96, v96
    v_exp_f32 v97, v97
    v_exp_f32 v98, v98
    v_mfma_f32_32x32x16_bf16 v[112:127], v[24:27], v[16:19], v[176:191]
    s_cmp_eq_u32 s21, 2
    s_cbranch_scc0 gated_mix__mha_block__softmax_full_mha__prompt_kernel_st2
    s_add_u32 s29, s100, 0
    buffer_store_dwordx4 v[208:211], v248, s[12:15], s29 offen offset:0 sc1
    buffer_store_dwordx4 v[212:215], v248, s[12:15], s29 offen offset:128 sc1
    buffer_store_dwordx4 v[216:219], v249, s[12:15], s29 offen offset:2048 sc1
    buffer_store_dwordx4 v[220:223], v249, s[12:15], s29 offen offset:2304 sc1
    s_add_u32 s29, s100, 4096
    buffer_store_dwordx4 v[224:227], v248, s[12:15], s29 offen offset:0 sc1
    buffer_store_dwordx4 v[228:231], v248, s[12:15], s29 offen offset:128 sc1
    buffer_store_dwordx4 v[232:235], v249, s[12:15], s29 offen offset:2048 sc1
    buffer_store_dwordx4 v[236:239], v249, s[12:15], s29 offen offset:2304 sc1
gated_mix__mha_block__softmax_full_mha__prompt_kernel_st2:
    v_exp_f32 v99, v99
    v_cvt_pk_bf16_f32 v56, v96, v97
    v_exp_f32 v100, v100
    v_exp_f32 v101, v101
    v_cvt_pk_bf16_f32 v57, v98, v99
    v_mfma_f32_32x32x16_bf16 v[112:127], v[28:31], v[20:23], v[112:127]
    v_exp_f32 v102, v102
    v_exp_f32 v103, v103
    v_cvt_pk_bf16_f32 v58, v100, v101
    v_exp_f32 v104, v104
    v_exp_f32 v105, v105
    v_cvt_pk_bf16_f32 v59, v102, v103
    v_mfma_f32_32x32x16_bf16 v[144:159], v[48:51], v[64:67], v[144:159]
    v_exp_f32 v106, v106
    v_exp_f32 v107, v107
    v_cvt_pk_bf16_f32 v60, v104, v105
    v_exp_f32 v108, v108
    v_exp_f32 v109, v109
    v_cvt_pk_bf16_f32 v61, v106, v107
    v_smfmac_f32_16x16x64_bf16 v[76:79], v[252:255], v[64:71], v250
    v_exp_f32 v110, v110
    v_exp_f32 v111, v111
    v_cvt_pk_bf16_f32 v62, v108, v109
    v_mfma_f32_32x32x16_bf16 v[144:159], v[52:55], v[68:71], v[144:159]
    v_cvt_pk_bf16_f32 v63, v110, v111
    s_waitcnt lgkmcnt(0)
    s_cmp_eq_u32 s21, 1
    s_cbranch_scc0 gated_mix__mha_block__softmax_full_mha__prompt_kernel_sg1
    s_waitcnt vmcnt(0)
    v_mov_b32 v3, 1
    v_cmp_gt_u32 vcc, 1, v1
    s_and_saveexec_b64 s[16:17], vcc
    buffer_atomic_add v3, v242, s[12:15], 0 offen offset:4 sc1
    s_mov_b64 exec, s[16:17]
gated_mix__mha_block__softmax_full_mha__prompt_kernel_sg1:
    s_cmp_eq_u32 s20, 0
    s_cbranch_scc0 gated_mix__mha_block__softmax_full_mha__prompt_kernel_pl0
    buffer_load_dword v244, v92, s[12:15], 0 offen sc1
gated_mix__mha_block__softmax_full_mha__prompt_kernel_pl0:
    v_exp_f32 v112, v112
    v_exp_f32 v113, v113
    v_exp_f32 v114, v114
    v_mfma_f32_32x32x16_bf16 v[96:111], v[32:35], v[8:11], v[160:175]
    ds_read_b128 v[24:27], v251 offset:32768
    v_exp_f32 v115, v115
    v_cvt_pk_bf16_f32 v64, v112, v113
    v_exp_f32 v116, v116
    v_exp_f32 v117, v117
    v_cvt_pk_bf16_f32 v65, v114, v115
    v_mfma_f32_32x32x16_bf16 v[96:111], v[36:39], v[12:15], v[96:111]
    ds_read_b128 v[28:31], v251 offset:33792
    v_exp_f32 v118, v118
    v_exp_f32 v119, v119
    v_cvt_pk_bf16_f32 v66, v116, v117
    v_exp_f32 v120, v120
    v_exp_f32 v121, v121
    v_cvt_pk_bf16_f32 v67, v118, v119
    v_mfma_f32_32x32x16_bf16 v[128:143], v[40:43], v[56:59], v[128:143]
    ds_read_b128 v[48:51], v251 offset:22528
    v_exp_f32 v122, v122
    v_exp_f32 v123, v123
    v_cvt_pk_bf16_f32 v68, v120, v121
    v_exp_f32 v124, v124
    v_exp_f32 v125, v125
    v_cvt_pk_bf16_f32 v69, v122, v123
    v_smfmac_f32_16x16x64_bf16 v[72:75], v[252:255], v[56:63], v250
    ds_read_b128 v[52:55], v251 offset:23552
    v_exp_f32 v126, v126
    v_exp_f32 v127, v127
    v_cvt_pk_bf16_f32 v70, v124, v125
    v_mfma_f32_32x32x16_bf16 v[128:143], v[44:47], v[60:63], v[128:143]
    v_cvt_pk_bf16_f32 v71, v126, v127
    v_exp_f32 v96, v96
    v_exp_f32 v97, v97
    v_exp_f32 v98, v98
    v_mfma_f32_32x32x16_bf16 v[112:127], v[32:35], v[16:19], v[176:191]
    s_waitcnt lgkmcnt(0)
    v_exp_f32 v99, v99
    v_cvt_pk_bf16_f32 v56, v96, v97
    v_exp_f32 v100, v100
    v_exp_f32 v101, v101
    v_cvt_pk_bf16_f32 v57, v98, v99
    v_mfma_f32_32x32x16_bf16 v[112:127], v[36:39], v[20:23], v[112:127]
    v_exp_f32 v102, v102
    v_exp_f32 v103, v103
    v_cvt_pk_bf16_f32 v58, v100, v101
    v_exp_f32 v104, v104
    v_exp_f32 v105, v105
    v_cvt_pk_bf16_f32 v59, v102, v103
    v_mfma_f32_32x32x16_bf16 v[144:159], v[40:43], v[64:67], v[144:159]
    v_exp_f32 v106, v106
    v_exp_f32 v107, v107
    v_cvt_pk_bf16_f32 v60, v104, v105
    v_exp_f32 v108, v108
    v_exp_f32 v109, v109
    v_cvt_pk_bf16_f32 v61, v106, v107
    v_smfmac_f32_16x16x64_bf16 v[76:79], v[252:255], v[64:71], v250
    v_exp_f32 v110, v110
    v_exp_f32 v111, v111
    v_cvt_pk_bf16_f32 v62, v108, v109
    v_mfma_f32_32x32x16_bf16 v[144:159], v[44:47], v[68:71], v[144:159]
    v_cvt_pk_bf16_f32 v63, v110, v111
    v_exp_f32 v112, v112
    v_exp_f32 v113, v113
    v_exp_f32 v114, v114
    v_mfma_f32_32x32x16_bf16 v[96:111], v[24:27], v[8:11], v[160:175]
    ds_read_b128 v[32:35], v251 offset:36864
    v_exp_f32 v115, v115
    v_cvt_pk_bf16_f32 v64, v112, v113
    v_exp_f32 v116, v116
    v_exp_f32 v117, v117
    v_cvt_pk_bf16_f32 v65, v114, v115
    v_mfma_f32_32x32x16_bf16 v[96:111], v[28:31], v[12:15], v[96:111]
    ds_read_b128 v[36:39], v251 offset:37888
    v_exp_f32 v118, v118
    v_exp_f32 v119, v119
    v_cvt_pk_bf16_f32 v66, v116, v117
    v_exp_f32 v120, v120
    v_exp_f32 v121, v121
    v_cvt_pk_bf16_f32 v67, v118, v119
    v_mfma_f32_32x32x16_bf16 v[128:143], v[48:51], v[56:59], v[128:143]
    ds_read_b128 v[40:43], v251 offset:34816
    v_exp_f32 v122, v122
    v_exp_f32 v123, v123
    v_cvt_pk_bf16_f32 v68, v120, v121
    v_exp_f32 v124, v124
    v_exp_f32 v125, v125
    v_cvt_pk_bf16_f32 v69, v122, v123
    v_smfmac_f32_16x16x64_bf16 v[72:75], v[252:255], v[56:63], v250
    ds_read_b128 v[44:47], v251 offset:35840
    v_exp_f32 v126, v126
    v_exp_f32 v127, v127
    v_cvt_pk_bf16_f32 v70, v124, v125
    v_mfma_f32_32x32x16_bf16 v[128:143], v[52:55], v[60:63], v[128:143]
    v_cvt_pk_bf16_f32 v71, v126, v127
    v_exp_f32 v96, v96
    v_exp_f32 v97, v97
    v_exp_f32 v98, v98
    v_mfma_f32_32x32x16_bf16 v[112:127], v[24:27], v[16:19], v[176:191]
    s_cmp_eq_u32 s21, 3
    s_cbranch_scc0 gated_mix__mha_block__softmax_full_mha__prompt_kernel_st3
    s_add_u32 s29, s100, 0
    buffer_store_dwordx4 v[208:211], v248, s[12:15], s29 offen offset:0 sc1
    buffer_store_dwordx4 v[212:215], v248, s[12:15], s29 offen offset:128 sc1
    buffer_store_dwordx4 v[216:219], v249, s[12:15], s29 offen offset:2048 sc1
    buffer_store_dwordx4 v[220:223], v249, s[12:15], s29 offen offset:2304 sc1
    s_add_u32 s29, s100, 4096
    buffer_store_dwordx4 v[224:227], v248, s[12:15], s29 offen offset:0 sc1
    buffer_store_dwordx4 v[228:231], v248, s[12:15], s29 offen offset:128 sc1
    buffer_store_dwordx4 v[232:235], v249, s[12:15], s29 offen offset:2048 sc1
    buffer_store_dwordx4 v[236:239], v249, s[12:15], s29 offen offset:2304 sc1
gated_mix__mha_block__softmax_full_mha__prompt_kernel_st3:
    v_exp_f32 v99, v99
    v_cvt_pk_bf16_f32 v56, v96, v97
    v_exp_f32 v100, v100
    v_exp_f32 v101, v101
    v_cvt_pk_bf16_f32 v57, v98, v99
    v_mfma_f32_32x32x16_bf16 v[112:127], v[28:31], v[20:23], v[112:127]
    v_exp_f32 v102, v102
    v_exp_f32 v103, v103
    v_cvt_pk_bf16_f32 v58, v100, v101
    v_exp_f32 v104, v104
    v_exp_f32 v105, v105
    v_cvt_pk_bf16_f32 v59, v102, v103
    v_mfma_f32_32x32x16_bf16 v[144:159], v[48:51], v[64:67], v[144:159]
    v_exp_f32 v106, v106
    v_exp_f32 v107, v107
    v_cvt_pk_bf16_f32 v60, v104, v105
    v_exp_f32 v108, v108
    v_exp_f32 v109, v109
    v_cvt_pk_bf16_f32 v61, v106, v107
    v_smfmac_f32_16x16x64_bf16 v[76:79], v[252:255], v[64:71], v250
    v_exp_f32 v110, v110
    v_exp_f32 v111, v111
    v_cvt_pk_bf16_f32 v62, v108, v109
    v_mfma_f32_32x32x16_bf16 v[144:159], v[52:55], v[68:71], v[144:159]
    v_cvt_pk_bf16_f32 v63, v110, v111
    s_cmp_eq_u32 s21, 2
    s_cbranch_scc0 gated_mix__mha_block__softmax_full_mha__prompt_kernel_sg2
    s_waitcnt vmcnt(0)
    v_mov_b32 v3, 1
    v_cmp_gt_u32 vcc, 1, v1
    s_and_saveexec_b64 s[16:17], vcc
    buffer_atomic_add v3, v242, s[12:15], 0 offen offset:8 sc1
    s_mov_b64 exec, s[16:17]
gated_mix__mha_block__softmax_full_mha__prompt_kernel_sg2:
    s_cmp_eq_u32 s20, 0
    s_cbranch_scc0 gated_mix__mha_block__softmax_full_mha__prompt_kernel_w2
    s_waitcnt vmcnt(0)
gated_mix__mha_block__softmax_full_mha__prompt_kernel_w2:
    s_cmp_eq_u32 s20, 0
    s_cbranch_scc0 gated_mix__mha_block__softmax_full_mha__prompt_kernel_ck0
    s_mov_b32 s18, 6000
gated_mix__mha_block__softmax_full_mha__prompt_kernel_sp1_l:
    s_add_u32 s29, s35, 0
    s_nop 3
    v_readlane_b32 s28, v244, s29
    s_nop 0
    s_cmp_ge_u32 s28, 2
    s_cbranch_scc1 gated_mix__mha_block__softmax_full_mha__prompt_kernel_sp1_ok
    s_sub_u32 s18, s18, 1
    s_cmp_eq_u32 s18, 0
    s_cbranch_scc1 gated_mix__mha_block__softmax_full_mha__prompt_kernel_sp1_ok
    buffer_load_dword v244, v92, s[12:15], 0 offen sc1
    s_waitcnt vmcnt(0)
    s_branch gated_mix__mha_block__softmax_full_mha__prompt_kernel_sp1_l
gated_mix__mha_block__softmax_full_mha__prompt_kernel_sp1_ok:
gated_mix__mha_block__softmax_full_mha__prompt_kernel_ck0:
    s_waitcnt lgkmcnt(0)
    s_barrier
    s_cmp_eq_u32 s20, 0
    s_cbranch_scc0 gated_mix__mha_block__softmax_full_mha__prompt_kernel_pl1
    buffer_load_dword v244, v92, s[12:15], 0 offen sc1
gated_mix__mha_block__softmax_full_mha__prompt_kernel_pl1:
    v_exp_f32 v112, v112
    v_exp_f32 v113, v113
    v_exp_f32 v114, v114
    v_mfma_f32_32x32x16_bf16 v[96:111], v[32:35], v[8:11], v[160:175]
    ds_read_b128 v[24:27], v251 offset:49152
    v_exp_f32 v115, v115
    v_cvt_pk_bf16_f32 v64, v112, v113
    v_exp_f32 v116, v116
    v_exp_f32 v117, v117
    v_cvt_pk_bf16_f32 v65, v114, v115
    v_mfma_f32_32x32x16_bf16 v[96:111], v[36:39], v[12:15], v[96:111]
    ds_read_b128 v[28:31], v251 offset:50176
    v_exp_f32 v118, v118
    v_exp_f32 v119, v119
    v_cvt_pk_bf16_f32 v66, v116, v117
    v_exp_f32 v120, v120
    v_exp_f32 v121, v121
    v_cvt_pk_bf16_f32 v67, v118, v119
    v_mfma_f32_32x32x16_bf16 v[128:143], v[40:43], v[56:59], v[128:143]
    ds_read_b128 v[48:51], v251 offset:38912
    v_exp_f32 v122, v122
    v_exp_f32 v123, v123
    v_cvt_pk_bf16_f32 v68, v120, v121
    v_exp_f32 v124, v124
    v_exp_f32 v125, v125
    v_cvt_pk_bf16_f32 v69, v122, v123
    v_smfmac_f32_16x16x64_bf16 v[72:75], v[252:255], v[56:63], v250
    ds_read_b128 v[52:55], v251 offset:39936
    v_exp_f32 v126, v126
    v_exp_f32 v127, v127
    v_cvt_pk_bf16_f32 v70, v124, v125
    v_mfma_f32_32x32x16_bf16 v[128:143], v[44:47], v[60:63], v[128:143]
    v_cvt_pk_bf16_f32 v71, v126, v127
    v_exp_f32 v96, v96
    v_exp_f32 v97, v97
    v_exp_f32 v98, v98
    v_mfma_f32_32x32x16_bf16 v[112:127], v[32:35], v[16:19], v[176:191]
    s_add_u32 m0, s97, 0
    s_add_u32 s29, s98, 0
    v_exp_f32 v99, v99
    v_cvt_pk_bf16_f32 v56, v96, v97
    v_exp_f32 v100, v100
    v_exp_f32 v101, v101
    v_cvt_pk_bf16_f32 v57, v98, v99
    v_mfma_f32_32x32x16_bf16 v[112:127], v[36:39], v[20:23], v[112:127]
    buffer_load_dwordx4 v5, s[12:15], s29 offen sc1 lds
    v_exp_f32 v102, v102
    v_exp_f32 v103, v103
    v_cvt_pk_bf16_f32 v58, v100, v101
    v_exp_f32 v104, v104
    v_exp_f32 v105, v105
    v_cvt_pk_bf16_f32 v59, v102, v103
    v_mfma_f32_32x32x16_bf16 v[144:159], v[40:43], v[64:67], v[144:159]
    buffer_load_dwordx4 v5, s[12:15], s29 offen offset:1024 sc1 lds
    v_exp_f32 v106, v106
    v_exp_f32 v107, v107
    v_cvt_pk_bf16_f32 v60, v104, v105
    v_exp_f32 v108, v108
    v_exp_f32 v109, v109
    v_cvt_pk_bf16_f32 v61, v106, v107
    v_smfmac_f32_16x16x64_bf16 v[76:79], v[252:255], v[64:71], v250
    s_waitcnt lgkmcnt(0)
    v_exp_f32 v110, v110
    v_exp_f32 v111, v111
    v_cvt_pk_bf16_f32 v62, v108, v109
    v_mfma_f32_32x32x16_bf16 v[144:159], v[44:47], v[68:71], v[144:159]
    v_cvt_pk_bf16_f32 v63, v110, v111
    v_exp_f32 v112, v112
    v_exp_f32 v113, v113
    v_exp_f32 v114, v114
    v_mfma_f32_32x32x16_bf16 v[96:111], v[24:27], v[8:11], v[160:175]
    ds_read_b128 v[32:35], v251 offset:53248
    v_exp_f32 v115, v115
    v_cvt_pk_bf16_f32 v64, v112, v113
    v_exp_f32 v116, v116
    v_exp_f32 v117, v117
    v_cvt_pk_bf16_f32 v65, v114, v115
    v_mfma_f32_32x32x16_bf16 v[96:111], v[28:31], v[12:15], v[96:111]
    ds_read_b128 v[36:39], v251 offset:54272
    v_exp_f32 v118, v118
    v_exp_f32 v119, v119
    v_cvt_pk_bf16_f32 v66, v116, v117
    v_exp_f32 v120, v120
    v_exp_f32 v121, v121
    v_cvt_pk_bf16_f32 v67, v118, v119
    v_mfma_f32_32x32x16_bf16 v[128:143], v[48:51], v[56:59], v[128:143]
    ds_read_b128 v[40:43], v251 offset:51200
    v_exp_f32 v122, v122
    v_exp_f32 v123, v123
    v_cvt_pk_bf16_f32 v68, v120, v121
    v_exp_f32 v124, v124
    v_exp_f32 v125, v125
    v_cvt_pk_bf16_f32 v69, v122, v123
    v_smfmac_f32_16x16x64_bf16 v[72:75], v[252:255], v[56:63], v250
    ds_read_b128 v[44:47], v251 offset:52224
    v_exp_f32 v126, v126
    v_exp_f32 v127, v127
    v_cvt_pk_bf16_f32 v70, v124, v125
    v_mfma_f32_32x32x16_bf16 v[128:143], v[52:55], v[60:63], v[128:143]
    v_cvt_pk_bf16_f32 v71, v126, v127
    v_exp_f32 v96, v96
    v_exp_f32 v97, v97
    v_exp_f32 v98, v98
    v_mfma_f32_32x32x16_bf16 v[112:127], v[24:27], v[16:19], v[176:191]
    v_exp_f32 v99, v99
    v_cvt_pk_bf16_f32 v56, v96, v97
    v_exp_f32 v100, v100
    v_exp_f32 v101, v101
    v_cvt_pk_bf16_f32 v57, v98, v99
    v_mfma_f32_32x32x16_bf16 v[112:127], v[28:31], v[20:23], v[112:127]
    v_exp_f32 v102, v102
    v_exp_f32 v103, v103
    v_cvt_pk_bf16_f32 v58, v100, v101
    v_exp_f32 v104, v104
    v_exp_f32 v105, v105
    v_cvt_pk_bf16_f32 v59, v102, v103
    v_mfma_f32_32x32x16_bf16 v[144:159], v[48:51], v[64:67], v[144:159]
    v_exp_f32 v106, v106
    v_exp_f32 v107, v107
    v_cvt_pk_bf16_f32 v60, v104, v105
    v_exp_f32 v108, v108
    v_exp_f32 v109, v109
    v_cvt_pk_bf16_f32 v61, v106, v107
    v_smfmac_f32_16x16x64_bf16 v[76:79], v[252:255], v[64:71], v250
    v_exp_f32 v110, v110
    v_exp_f32 v111, v111
    v_cvt_pk_bf16_f32 v62, v108, v109
    v_mfma_f32_32x32x16_bf16 v[144:159], v[52:55], v[68:71], v[144:159]
    v_cvt_pk_bf16_f32 v63, v110, v111
    s_waitcnt vmcnt(0) lgkmcnt(0)
    s_cmp_eq_u32 s21, 3
    s_cbranch_scc0 gated_mix__mha_block__softmax_full_mha__prompt_kernel_sg3
    v_mov_b32 v3, 1
    v_cmp_gt_u32 vcc, 1, v1
    s_and_saveexec_b64 s[16:17], vcc
    buffer_atomic_add v3, v242, s[12:15], 0 offen offset:12 sc1
    s_mov_b64 exec, s[16:17]
gated_mix__mha_block__softmax_full_mha__prompt_kernel_sg3:
    s_cmp_eq_u32 s20, 0
    s_cbranch_scc0 gated_mix__mha_block__softmax_full_mha__prompt_kernel_ck1
    s_mov_b32 s18, 6000
gated_mix__mha_block__softmax_full_mha__prompt_kernel_sp2_l:
    s_add_u32 s29, s35, 1
    s_nop 3
    v_readlane_b32 s28, v244, s29
    s_nop 0
    s_cmp_ge_u32 s28, 2
    s_cbranch_scc1 gated_mix__mha_block__softmax_full_mha__prompt_kernel_sp2_ok
    s_sub_u32 s18, s18, 1
    s_cmp_eq_u32 s18, 0
    s_cbranch_scc1 gated_mix__mha_block__softmax_full_mha__prompt_kernel_sp2_ok
    buffer_load_dword v244, v92, s[12:15], 0 offen sc1
    s_waitcnt vmcnt(0)
    s_branch gated_mix__mha_block__softmax_full_mha__prompt_kernel_sp2_l
gated_mix__mha_block__softmax_full_mha__prompt_kernel_sp2_ok:
gated_mix__mha_block__softmax_full_mha__prompt_kernel_ck1:
    s_barrier
    s_cmp_eq_u32 s20, 0
    s_cbranch_scc0 gated_mix__mha_block__softmax_full_mha__prompt_kernel_pl2
    buffer_load_dword v244, v92, s[12:15], 0 offen sc1
gated_mix__mha_block__softmax_full_mha__prompt_kernel_pl2:
    v_exp_f32 v112, v112
    v_exp_f32 v113, v113
    v_exp_f32 v114, v114
    v_mfma_f32_32x32x16_bf16 v[96:111], v[32:35], v[8:11], v[160:175]
    ds_read_b128 v[24:27], v241 offset:0
    v_exp_f32 v115, v115
    v_cvt_pk_bf16_f32 v64, v112, v113
    v_exp_f32 v116, v116
    v_exp_f32 v117, v117
    v_cvt_pk_bf16_f32 v65, v114, v115
    v_mfma_f32_32x32x16_bf16 v[96:111], v[36:39], v[12:15], v[96:111]
    ds_read_b128 v[28:31], v241 offset:1024
    v_exp_f32 v118, v118
    v_exp_f32 v119, v119
    v_cvt_pk_bf16_f32 v66, v116, v117
    v_exp_f32 v120, v120
    v_exp_f32 v121, v121
    v_cvt_pk_bf16_f32 v67, v118, v119
    v_mfma_f32_32x32x16_bf16 v[128:143], v[40:43], v[56:59], v[128:143]
    ds_read_b128 v[48:51], v251 offset:55296
    v_exp_f32 v122, v122
    v_exp_f32 v123, v123
    v_cvt_pk_bf16_f32 v68, v120, v121
    v_exp_f32 v124, v124
    v_exp_f32 v125, v125
    v_cvt_pk_bf16_f32 v69, v122, v123
    v_smfmac_f32_16x16x64_bf16 v[72:75], v[252:255], v[56:63], v250
    ds_read_b128 v[52:55], v251 offset:56320
    v_exp_f32 v126, v126
    v_exp_f32 v127, v127
    v_cvt_pk_bf16_f32 v70, v124, v125
    v_mfma_f32_32x32x16_bf16 v[128:143], v[44:47], v[60:63], v[128:143]
    v_cvt_pk_bf16_f32 v71, v126, v127
    v_exp_f32 v96, v96
    v_exp_f32 v97, v97
    v_exp_f32 v98, v98
    v_mfma_f32_32x32x16_bf16 v[112:127], v[32:35], v[16:19], v[176:191]
    s_add_u32 m0, s97, 16384
    s_add_u32 s29, s98, 8192
    v_exp_f32 v99, v99
    v_cvt_pk_bf16_f32 v56, v96, v97
    v_exp_f32 v100, v100
    v_exp_f32 v101, v101
    v_cvt_pk_bf16_f32 v57, v98, v99
    v_mfma_f32_32x32x16_bf16 v[112:127], v[36:39], v[20:23], v[112:127]
    buffer_load_dwordx4 v5, s[12:15], s29 offen sc1 lds
    v_exp_f32 v102, v102
    v_exp_f32 v103, v103
    v_cvt_pk_bf16_f32 v58, v100, v101
    v_exp_f32 v104, v104
    v_exp_f32 v105, v105
    v_cvt_pk_bf16_f32 v59, v102, v103
    v_mfma_f32_32x32x16_bf16 v[144:159], v[40:43], v[64:67], v[144:159]
    buffer_load_dwordx4 v5, s[12:15], s29 offen offset:1024 sc1 lds
    v_exp_f32 v106, v106
    v_exp_f32 v107, v107
    v_cvt_pk_bf16_f32 v60, v104, v105
    v_exp_f32 v108, v108
    v_exp_f32 v109, v109
    v_cvt_pk_bf16_f32 v61, v106, v107
    v_smfmac_f32_16x16x64_bf16 v[76:79], v[252:255], v[64:71], v250
    s_waitcnt lgkmcnt(0)
    v_exp_f32 v110, v110
    v_exp_f32 v111, v111
    v_cvt_pk_bf16_f32 v62, v108, v109
    v_mfma_f32_32x32x16_bf16 v[144:159], v[44:47], v[68:71], v[144:159]
    v_cvt_pk_bf16_f32 v63, v110, v111
    v_exp_f32 v112, v112
    v_exp_f32 v113, v113
    v_exp_f32 v114, v114
    v_mfma_f32_32x32x16_bf16 v[96:111], v[24:27], v[8:11], v[160:175]
    ds_read_b128 v[32:35], v241 offset:4096
    v_exp_f32 v115, v115
    v_cvt_pk_bf16_f32 v64, v112, v113
    v_exp_f32 v116, v116
    v_exp_f32 v117, v117
    v_cvt_pk_bf16_f32 v65, v114, v115
    v_mfma_f32_32x32x16_bf16 v[96:111], v[28:31], v[12:15], v[96:111]
    ds_read_b128 v[36:39], v241 offset:5120
    v_exp_f32 v118, v118
    v_exp_f32 v119, v119
    v_cvt_pk_bf16_f32 v66, v116, v117
    v_exp_f32 v120, v120
    v_exp_f32 v121, v121
    v_cvt_pk_bf16_f32 v67, v118, v119
    v_mfma_f32_32x32x16_bf16 v[128:143], v[48:51], v[56:59], v[128:143]
    ds_read_b128 v[40:43], v241 offset:2048
    v_exp_f32 v122, v122
    v_exp_f32 v123, v123
    v_cvt_pk_bf16_f32 v68, v120, v121
    v_exp_f32 v124, v124
    v_exp_f32 v125, v125
    v_cvt_pk_bf16_f32 v69, v122, v123
    v_smfmac_f32_16x16x64_bf16 v[72:75], v[252:255], v[56:63], v250
    ds_read_b128 v[44:47], v241 offset:3072
    v_exp_f32 v126, v126
    v_exp_f32 v127, v127
    v_cvt_pk_bf16_f32 v70, v124, v125
    v_mfma_f32_32x32x16_bf16 v[128:143], v[52:55], v[60:63], v[128:143]
    v_cvt_pk_bf16_f32 v71, v126, v127
    v_exp_f32 v96, v96
    v_exp_f32 v97, v97
    v_exp_f32 v98, v98
    v_mfma_f32_32x32x16_bf16 v[112:127], v[24:27], v[16:19], v[176:191]
    v_exp_f32 v99, v99
    v_cvt_pk_bf16_f32 v56, v96, v97
    v_exp_f32 v100, v100
    v_exp_f32 v101, v101
    v_cvt_pk_bf16_f32 v57, v98, v99
    v_mfma_f32_32x32x16_bf16 v[112:127], v[28:31], v[20:23], v[112:127]
    v_exp_f32 v102, v102
    v_exp_f32 v103, v103
    v_cvt_pk_bf16_f32 v58, v100, v101
    v_exp_f32 v104, v104
    v_exp_f32 v105, v105
    v_cvt_pk_bf16_f32 v59, v102, v103
    v_mfma_f32_32x32x16_bf16 v[144:159], v[48:51], v[64:67], v[144:159]
    v_exp_f32 v106, v106
    v_exp_f32 v107, v107
    v_cvt_pk_bf16_f32 v60, v104, v105
    v_exp_f32 v108, v108
    v_exp_f32 v109, v109
    v_cvt_pk_bf16_f32 v61, v106, v107
    v_smfmac_f32_16x16x64_bf16 v[76:79], v[252:255], v[64:71], v250
    v_exp_f32 v110, v110
    v_exp_f32 v111, v111
    v_cvt_pk_bf16_f32 v62, v108, v109
    v_mfma_f32_32x32x16_bf16 v[144:159], v[52:55], v[68:71], v[144:159]
    v_cvt_pk_bf16_f32 v63, v110, v111
    s_waitcnt vmcnt(0) lgkmcnt(0)
    s_cmp_eq_u32 s20, 0
    s_cbranch_scc0 gated_mix__mha_block__softmax_full_mha__prompt_kernel_ck2
    s_mov_b32 s18, 6000
gated_mix__mha_block__softmax_full_mha__prompt_kernel_sp3_l:
    s_add_u32 s29, s35, 2
    s_nop 3
    v_readlane_b32 s28, v244, s29
    s_nop 0
    s_cmp_ge_u32 s28, 2
    s_cbranch_scc1 gated_mix__mha_block__softmax_full_mha__prompt_kernel_sp3_ok
    s_sub_u32 s18, s18, 1
    s_cmp_eq_u32 s18, 0
    s_cbranch_scc1 gated_mix__mha_block__softmax_full_mha__prompt_kernel_sp3_ok
    buffer_load_dword v244, v92, s[12:15], 0 offen sc1
    s_waitcnt vmcnt(0)
    s_branch gated_mix__mha_block__softmax_full_mha__prompt_kernel_sp3_l
gated_mix__mha_block__softmax_full_mha__prompt_kernel_sp3_ok:
gated_mix__mha_block__softmax_full_mha__prompt_kernel_ck2:
    s_barrier
    s_cmp_eq_u32 s20, 0
    s_cbranch_scc0 gated_mix__mha_block__softmax_full_mha__prompt_kernel_pl3
    buffer_load_dword v244, v92, s[12:15], 0 offen sc1
gated_mix__mha_block__softmax_full_mha__prompt_kernel_pl3:
    v_exp_f32 v112, v112
    v_exp_f32 v113, v113
    v_exp_f32 v114, v114
    v_mfma_f32_32x32x16_bf16 v[96:111], v[32:35], v[8:11], v[160:175]
    ds_read_b128 v[24:27], v241 offset:16384
    v_exp_f32 v115, v115
    v_cvt_pk_bf16_f32 v64, v112, v113
    v_exp_f32 v116, v116
    v_exp_f32 v117, v117
    v_cvt_pk_bf16_f32 v65, v114, v115
    v_mfma_f32_32x32x16_bf16 v[96:111], v[36:39], v[12:15], v[96:111]
    ds_read_b128 v[28:31], v241 offset:17408
    v_exp_f32 v118, v118
    v_exp_f32 v119, v119
    v_cvt_pk_bf16_f32 v66, v116, v117
    v_exp_f32 v120, v120
    v_exp_f32 v121, v121
    v_cvt_pk_bf16_f32 v67, v118, v119
    v_mfma_f32_32x32x16_bf16 v[128:143], v[40:43], v[56:59], v[128:143]
    ds_read_b128 v[48:51], v241 offset:6144
    v_exp_f32 v122, v122
    v_exp_f32 v123, v123
    v_cvt_pk_bf16_f32 v68, v120, v121
    v_exp_f32 v124, v124
    v_exp_f32 v125, v125
    v_cvt_pk_bf16_f32 v69, v122, v123
    v_smfmac_f32_16x16x64_bf16 v[72:75], v[252:255], v[56:63], v250
    ds_read_b128 v[52:55], v241 offset:7168
    v_exp_f32 v126, v126
    v_exp_f32 v127, v127
    v_cvt_pk_bf16_f32 v70, v124, v125
    v_mfma_f32_32x32x16_bf16 v[128:143], v[44:47], v[60:63], v[128:143]
    v_cvt_pk_bf16_f32 v71, v126, v127
    v_exp_f32 v96, v96
    v_exp_f32 v97, v97
    v_exp_f32 v98, v98
    v_mfma_f32_32x32x16_bf16 v[112:127], v[32:35], v[16:19], v[176:191]
    s_add_u32 m0, s97, 32768
    s_add_u32 s29, s98, 16384
    v_exp_f32 v99, v99
    v_cvt_pk_bf16_f32 v56, v96, v97
    v_exp_f32 v100, v100
    v_exp_f32 v101, v101
    v_cvt_pk_bf16_f32 v57, v98, v99
    v_mfma_f32_32x32x16_bf16 v[112:127], v[36:39], v[20:23], v[112:127]
    buffer_load_dwordx4 v5, s[12:15], s29 offen sc1 lds
    v_exp_f32 v102, v102
    v_exp_f32 v103, v103
    v_cvt_pk_bf16_f32 v58, v100, v101
    v_exp_f32 v104, v104
    v_exp_f32 v105, v105
    v_cvt_pk_bf16_f32 v59, v102, v103
    v_mfma_f32_32x32x16_bf16 v[144:159], v[40:43], v[64:67], v[144:159]
    buffer_load_dwordx4 v5, s[12:15], s29 offen offset:1024 sc1 lds
    v_exp_f32 v106, v106
    v_exp_f32 v107, v107
    v_cvt_pk_bf16_f32 v60, v104, v105
    v_exp_f32 v108, v108
    v_exp_f32 v109, v109
    v_cvt_pk_bf16_f32 v61, v106, v107
    v_smfmac_f32_16x16x64_bf16 v[76:79], v[252:255], v[64:71], v250
    s_waitcnt lgkmcnt(0)
    v_exp_f32 v110, v110
    v_exp_f32 v111, v111
    v_cvt_pk_bf16_f32 v62, v108, v109
    v_mfma_f32_32x32x16_bf16 v[144:159], v[44:47], v[68:71], v[144:159]
    v_cvt_pk_bf16_f32 v63, v110, v111
    v_exp_f32 v112, v112
    v_exp_f32 v113, v113
    v_exp_f32 v114, v114
    v_mfma_f32_32x32x16_bf16 v[96:111], v[24:27], v[8:11], v[160:175]
    ds_read_b128 v[32:35], v241 offset:20480
    v_exp_f32 v115, v115
    v_cvt_pk_bf16_f32 v64, v112, v113
    v_exp_f32 v116, v116
    v_exp_f32 v117, v117
    v_cvt_pk_bf16_f32 v65, v114, v115
    v_mfma_f32_32x32x16_bf16 v[96:111], v[28:31], v[12:15], v[96:111]
    ds_read_b128 v[36:39], v241 offset:21504
    v_exp_f32 v118, v118
    v_exp_f32 v119, v119
    v_cvt_pk_bf16_f32 v66, v116, v117
    v_exp_f32 v120, v120
    v_exp_f32 v121, v121
    v_cvt_pk_bf16_f32 v67, v118, v119
    v_mfma_f32_32x32x16_bf16 v[128:143], v[48:51], v[56:59], v[128:143]
    ds_read_b128 v[40:43], v241 offset:18432
    v_exp_f32 v122, v122
    v_exp_f32 v123, v123
    v_cvt_pk_bf16_f32 v68, v120, v121
    v_exp_f32 v124, v124
    v_exp_f32 v125, v125
    v_cvt_pk_bf16_f32 v69, v122, v123
    v_smfmac_f32_16x16x64_bf16 v[72:75], v[252:255], v[56:63], v250
    ds_read_b128 v[44:47], v241 offset:19456
    v_exp_f32 v126, v126
    v_exp_f32 v127, v127
    v_cvt_pk_bf16_f32 v70, v124, v125
    v_mfma_f32_32x32x16_bf16 v[128:143], v[52:55], v[60:63], v[128:143]
    v_cvt_pk_bf16_f32 v71, v126, v127
    v_exp_f32 v96, v96
    v_exp_f32 v97, v97
    v_exp_f32 v98, v98
    v_mfma_f32_32x32x16_bf16 v[112:127], v[24:27], v[16:19], v[176:191]
    v_exp_f32 v99, v99
    v_cvt_pk_bf16_f32 v56, v96, v97
    v_exp_f32 v100, v100
    v_exp_f32 v101, v101
    v_cvt_pk_bf16_f32 v57, v98, v99
    v_mfma_f32_32x32x16_bf16 v[112:127], v[28:31], v[20:23], v[112:127]
    v_exp_f32 v102, v102
    v_exp_f32 v103, v103
    v_cvt_pk_bf16_f32 v58, v100, v101
    v_exp_f32 v104, v104
    v_exp_f32 v105, v105
    v_cvt_pk_bf16_f32 v59, v102, v103
    v_mfma_f32_32x32x16_bf16 v[144:159], v[48:51], v[64:67], v[144:159]
    v_exp_f32 v106, v106
    v_exp_f32 v107, v107
    v_cvt_pk_bf16_f32 v60, v104, v105
    v_exp_f32 v108, v108
    v_exp_f32 v109, v109
    v_cvt_pk_bf16_f32 v61, v106, v107
    v_smfmac_f32_16x16x64_bf16 v[76:79], v[252:255], v[64:71], v250
    v_exp_f32 v110, v110
    v_exp_f32 v111, v111
    v_cvt_pk_bf16_f32 v62, v108, v109
    v_mfma_f32_32x32x16_bf16 v[144:159], v[52:55], v[68:71], v[144:159]
    v_cvt_pk_bf16_f32 v63, v110, v111
    s_waitcnt vmcnt(0) lgkmcnt(0)
    s_cmp_eq_u32 s20, 0
    s_cbranch_scc0 gated_mix__mha_block__softmax_full_mha__prompt_kernel_ck3
    s_mov_b32 s18, 6000
gated_mix__mha_block__softmax_full_mha__prompt_kernel_sp4_l:
    v_cmp_le_u32 vcc, 2, v244
    s_nop 0
    s_cmp_eq_u64 vcc, -1
    s_cbranch_scc1 gated_mix__mha_block__softmax_full_mha__prompt_kernel_sp4_ok
    s_sub_u32 s18, s18, 1
    s_cmp_eq_u32 s18, 0
    s_cbranch_scc1 gated_mix__mha_block__softmax_full_mha__prompt_kernel_sp4_ok
    buffer_load_dword v244, v92, s[12:15], 0 offen sc1
    s_waitcnt vmcnt(0)
    s_branch gated_mix__mha_block__softmax_full_mha__prompt_kernel_sp4_l
gated_mix__mha_block__softmax_full_mha__prompt_kernel_sp4_ok:
gated_mix__mha_block__softmax_full_mha__prompt_kernel_ck3:
    s_barrier
    v_exp_f32 v112, v112
    v_exp_f32 v113, v113
    v_exp_f32 v114, v114
    v_mfma_f32_32x32x16_bf16 v[96:111], v[32:35], v[8:11], v[160:175]
    ds_read_b128 v[24:27], v241 offset:32768
    v_exp_f32 v115, v115
    v_cvt_pk_bf16_f32 v64, v112, v113
    v_exp_f32 v116, v116
    v_exp_f32 v117, v117
    v_cvt_pk_bf16_f32 v65, v114, v115
    v_mfma_f32_32x32x16_bf16 v[96:111], v[36:39], v[12:15], v[96:111]
    ds_read_b128 v[28:31], v241 offset:33792
    v_exp_f32 v118, v118
    v_exp_f32 v119, v119
    v_cvt_pk_bf16_f32 v66, v116, v117
    v_exp_f32 v120, v120
    v_exp_f32 v121, v121
    v_cvt_pk_bf16_f32 v67, v118, v119
    v_mfma_f32_32x32x16_bf16 v[128:143], v[40:43], v[56:59], v[128:143]
    ds_read_b128 v[48:51], v241 offset:22528
    v_exp_f32 v122, v122
    v_exp_f32 v123, v123
    v_cvt_pk_bf16_f32 v68, v120, v121
    v_exp_f32 v124, v124
    v_exp_f32 v125, v125
    v_cvt_pk_bf16_f32 v69, v122, v123
    v_smfmac_f32_16x16x64_bf16 v[72:75], v[252:255], v[56:63], v250
    ds_read_b128 v[52:55], v241 offset:23552
    v_exp_f32 v126, v126
    v_exp_f32 v127, v127
    v_cvt_pk_bf16_f32 v70, v124, v125
    v_mfma_f32_32x32x16_bf16 v[128:143], v[44:47], v[60:63], v[128:143]
    v_cvt_pk_bf16_f32 v71, v126, v127
    v_exp_f32 v96, v96
    v_exp_f32 v97, v97
    v_exp_f32 v98, v98
    v_mfma_f32_32x32x16_bf16 v[112:127], v[32:35], v[16:19], v[176:191]
    s_add_u32 m0, s97, 49152
    s_add_u32 s29, s98, 24576
    v_exp_f32 v99, v99
    v_cvt_pk_bf16_f32 v56, v96, v97
    v_exp_f32 v100, v100
    v_exp_f32 v101, v101
    v_cvt_pk_bf16_f32 v57, v98, v99
    v_mfma_f32_32x32x16_bf16 v[112:127], v[36:39], v[20:23], v[112:127]
    buffer_load_dwordx4 v5, s[12:15], s29 offen sc1 lds
    v_exp_f32 v102, v102
    v_exp_f32 v103, v103
    v_cvt_pk_bf16_f32 v58, v100, v101
    v_exp_f32 v104, v104
    v_exp_f32 v105, v105
    v_cvt_pk_bf16_f32 v59, v102, v103
    v_mfma_f32_32x32x16_bf16 v[144:159], v[40:43], v[64:67], v[144:159]
    buffer_load_dwordx4 v5, s[12:15], s29 offen offset:1024 sc1 lds
    v_exp_f32 v106, v106
    v_exp_f32 v107, v107
    v_cvt_pk_bf16_f32 v60, v104, v105
    v_exp_f32 v108, v108
    v_exp_f32 v109, v109
    v_cvt_pk_bf16_f32 v61, v106, v107
    v_smfmac_f32_16x16x64_bf16 v[76:79], v[252:255], v[64:71], v250
    s_waitcnt lgkmcnt(0)
    v_exp_f32 v110, v110
    v_exp_f32 v111, v111
    v_cvt_pk_bf16_f32 v62, v108, v109
    v_mfma_f32_32x32x16_bf16 v[144:159], v[44:47], v[68:71], v[144:159]
    v_cvt_pk_bf16_f32 v63, v110, v111
    v_exp_f32 v112, v112
    v_exp_f32 v113, v113
    v_exp_f32 v114, v114
    v_mfma_f32_32x32x16_bf16 v[96:111], v[24:27], v[8:11], v[160:175]
    ds_read_b128 v[32:35], v241 offset:36864
    v_exp_f32 v115, v115
    v_cvt_pk_bf16_f32 v64, v112, v113
    v_exp_f32 v116, v116
    v_exp_f32 v117, v117
    v_cvt_pk_bf16_f32 v65, v114, v115
    v_mfma_f32_32x32x16_bf16 v[96:111], v[28:31], v[12:15], v[96:111]
    ds_read_b128 v[36:39], v241 offset:37888
    v_exp_f32 v118, v118
    v_exp_f32 v119, v119
    v_cvt_pk_bf16_f32 v66, v116, v117
    v_exp_f32 v120, v120
    v_exp_f32 v121, v121
    v_cvt_pk_bf16_f32 v67, v118, v119
    v_mfma_f32_32x32x16_bf16 v[128:143], v[48:51], v[56:59], v[128:143]
    ds_read_b128 v[40:43], v241 offset:34816
    v_exp_f32 v122, v122
    v_exp_f32 v123, v123
    v_cvt_pk_bf16_f32 v68, v120, v121
    v_exp_f32 v124, v124
    v_exp_f32 v125, v125
    v_cvt_pk_bf16_f32 v69, v122, v123
    v_smfmac_f32_16x16x64_bf16 v[72:75], v[252:255], v[56:63], v250
    ds_read_b128 v[44:47], v241 offset:35840
    v_exp_f32 v126, v126
    v_exp_f32 v127, v127
    v_cvt_pk_bf16_f32 v70, v124, v125
    v_mfma_f32_32x32x16_bf16 v[128:143], v[52:55], v[60:63], v[128:143]
    v_cvt_pk_bf16_f32 v71, v126, v127
    v_exp_f32 v96, v96
    v_exp_f32 v97, v97
    v_exp_f32 v98, v98
    v_mfma_f32_32x32x16_bf16 v[112:127], v[24:27], v[16:19], v[176:191]
    s_add_u32 m0, s97, 0
    s_add_u32 s29, s99, 0
    v_exp_f32 v99, v99
    v_cvt_pk_bf16_f32 v56, v96, v97
    v_exp_f32 v100, v100
    v_exp_f32 v101, v101
    v_cvt_pk_bf16_f32 v57, v98, v99
    v_mfma_f32_32x32x16_bf16 v[112:127], v[28:31], v[20:23], v[112:127]
    buffer_load_dwordx4 v5, s[12:15], s29 offen sc1 lds
    v_exp_f32 v102, v102
    v_exp_f32 v103, v103
    v_cvt_pk_bf16_f32 v58, v100, v101
    v_exp_f32 v104, v104
    v_exp_f32 v105, v105
    v_cvt_pk_bf16_f32 v59, v102, v103
    v_mfma_f32_32x32x16_bf16 v[144:159], v[48:51], v[64:67], v[144:159]
    buffer_load_dwordx4 v5, s[12:15], s29 offen offset:1024 sc1 lds
    v_exp_f32 v106, v106
    v_exp_f32 v107, v107
    v_cvt_pk_bf16_f32 v60, v104, v105
    v_exp_f32 v108, v108
    v_exp_f32 v109, v109
    v_cvt_pk_bf16_f32 v61, v106, v107
    v_smfmac_f32_16x16x64_bf16 v[76:79], v[252:255], v[64:71], v250
    v_exp_f32 v110, v110
    v_exp_f32 v111, v111
    v_cvt_pk_bf16_f32 v62, v108, v109
    v_mfma_f32_32x32x16_bf16 v[144:159], v[52:55], v[68:71], v[144:159]
    s_waitcnt vmcnt(2) lgkmcnt(0)
    s_barrier
    v_cvt_pk_bf16_f32 v63, v110, v111
    s_mov_b32 s98, s99
    s_add_u32 s99, s24, 3
    s_and_b32 s99, s99, 7
    s_lshl_b32 s99, s99, 15
    s_add_u32 s99, s99, s96
    s_mov_b32 s32, 0
    s_mov_b32 s19, 4
gated_mix__mha_block__softmax_full_mha__prompt_kernel_loop:
    v_exp_f32 v112, v112
    v_exp_f32 v113, v113
    v_exp_f32 v114, v114
    v_mfma_f32_32x32x16_bf16 v[96:111], v[32:35], v[8:11], v[160:175]
    ds_read_b128 v[24:27], v241 offset:49152
    v_exp_f32 v115, v115
    v_cvt_pk_bf16_f32 v64, v112, v113
    v_exp_f32 v116, v116
    v_exp_f32 v117, v117
    v_cvt_pk_bf16_f32 v65, v114, v115
    v_mfma_f32_32x32x16_bf16 v[96:111], v[36:39], v[12:15], v[96:111]
    ds_read_b128 v[28:31], v241 offset:50176
    v_exp_f32 v118, v118
    v_exp_f32 v119, v119
    v_cvt_pk_bf16_f32 v66, v116, v117
    v_exp_f32 v120, v120
    v_exp_f32 v121, v121
    v_cvt_pk_bf16_f32 v67, v118, v119
    v_mfma_f32_32x32x16_bf16 v[128:143], v[40:43], v[56:59], v[128:143]
    ds_read_b128 v[48:51], v241 offset:38912
    v_exp_f32 v122, v122
    v_exp_f32 v123, v123
    v_cvt_pk_bf16_f32 v68, v120, v121
    v_exp_f32 v124, v124
    v_exp_f32 v125, v125
    v_cvt_pk_bf16_f32 v69, v122, v123
    v_smfmac_f32_16x16x64_bf16 v[72:75], v[252:255], v[56:63], v250
    ds_read_b128 v[52:55], v241 offset:39936
    v_exp_f32 v126, v126
    v_exp_f32 v127, v127
    v_cvt_pk_bf16_f32 v70, v124, v125
    v_mfma_f32_32x32x16_bf16 v[128:143], v[44:47], v[60:63], v[128:143]
    v_cvt_pk_bf16_f32 v71, v126, v127
    v_exp_f32 v96, v96
    v_exp_f32 v97, v97
    v_exp_f32 v98, v98
    v_mfma_f32_32x32x16_bf16 v[112:127], v[32:35], v[16:19], v[176:191]
    s_add_u32 m0, s97, 16384
    s_add_u32 s29, s98, 8192
    v_exp_f32 v99, v99
    v_cvt_pk_bf16_f32 v56, v96, v97
    v_exp_f32 v100, v100
    v_exp_f32 v101, v101
    v_cvt_pk_bf16_f32 v57, v98, v99
    v_mfma_f32_32x32x16_bf16 v[112:127], v[36:39], v[20:23], v[112:127]
    buffer_load_dwordx4 v5, s[12:15], s29 offen sc1 lds
    v_exp_f32 v102, v102
    v_exp_f32 v103, v103
    v_cvt_pk_bf16_f32 v58, v100, v101
    v_exp_f32 v104, v104
    v_exp_f32 v105, v105
    v_cvt_pk_bf16_f32 v59, v102, v103
    v_mfma_f32_32x32x16_bf16 v[144:159], v[40:43], v[64:67], v[144:159]
    buffer_load_dwordx4 v5, s[12:15], s29 offen offset:1024 sc1 lds
    v_exp_f32 v106, v106
    v_exp_f32 v107, v107
    v_cvt_pk_bf16_f32 v60, v104, v105
    v_exp_f32 v108, v108
    v_exp_f32 v109, v109
    v_cvt_pk_bf16_f32 v61, v106, v107
    v_smfmac_f32_16x16x64_bf16 v[76:79], v[252:255], v[64:71], v250
    s_waitcnt lgkmcnt(0)
    v_exp_f32 v110, v110
    v_exp_f32 v111, v111
    v_cvt_pk_bf16_f32 v62, v108, v109
    v_mfma_f32_32x32x16_bf16 v[144:159], v[44:47], v[68:71], v[144:159]
    v_cvt_pk_bf16_f32 v63, v110, v111
    v_exp_f32 v112, v112
    v_exp_f32 v113, v113
    v_exp_f32 v114, v114
    v_mfma_f32_32x32x16_bf16 v[96:111], v[24:27], v[8:11], v[160:175]
    ds_read_b128 v[32:35], v241 offset:53248
    v_exp_f32 v115, v115
    v_cvt_pk_bf16_f32 v64, v112, v113
    v_exp_f32 v116, v116
    v_exp_f32 v117, v117
    v_cvt_pk_bf16_f32 v65, v114, v115
    v_mfma_f32_32x32x16_bf16 v[96:111], v[28:31], v[12:15], v[96:111]
    ds_read_b128 v[36:39], v241 offset:54272
    v_exp_f32 v118, v118
    v_exp_f32 v119, v119
    v_cvt_pk_bf16_f32 v66, v116, v117
    v_exp_f32 v120, v120
    v_exp_f32 v121, v121
    v_cvt_pk_bf16_f32 v67, v118, v119
    v_mfma_f32_32x32x16_bf16 v[128:143], v[48:51], v[56:59], v[128:143]
    ds_read_b128 v[40:43], v241 offset:51200
    v_exp_f32 v122, v122
    v_exp_f32 v123, v123
    v_cvt_pk_bf16_f32 v68, v120, v121
    v_exp_f32 v124, v124
    v_exp_f32 v125, v125
    v_cvt_pk_bf16_f32 v69, v122, v123
    v_smfmac_f32_16x16x64_bf16 v[72:75], v[252:255], v[56:63], v250
    ds_read_b128 v[44:47], v241 offset:52224
    v_exp_f32 v126, v126
    v_exp_f32 v127, v127
    v_cvt_pk_bf16_f32 v70, v124, v125
    v_mfma_f32_32x32x16_bf16 v[128:143], v[52:55], v[60:63], v[128:143]
    v_cvt_pk_bf16_f32 v71, v126, v127
    v_exp_f32 v96, v96
    v_exp_f32 v97, v97
    v_exp_f32 v98, v98
    v_mfma_f32_32x32x16_bf16 v[112:127], v[24:27], v[16:19], v[176:191]
    v_exp_f32 v99, v99
    v_cvt_pk_bf16_f32 v56, v96, v97
    v_exp_f32 v100, v100
    v_exp_f32 v101, v101
    v_cvt_pk_bf16_f32 v57, v98, v99
    v_mfma_f32_32x32x16_bf16 v[112:127], v[28:31], v[20:23], v[112:127]
    v_exp_f32 v102, v102
    v_exp_f32 v103, v103
    v_cvt_pk_bf16_f32 v58, v100, v101
    v_exp_f32 v104, v104
    v_exp_f32 v105, v105
    v_cvt_pk_bf16_f32 v59, v102, v103
    v_mfma_f32_32x32x16_bf16 v[144:159], v[48:51], v[64:67], v[144:159]
    v_exp_f32 v106, v106
    v_exp_f32 v107, v107
    v_cvt_pk_bf16_f32 v60, v104, v105
    v_exp_f32 v108, v108
    v_exp_f32 v109, v109
    v_cvt_pk_bf16_f32 v61, v106, v107
    v_smfmac_f32_16x16x64_bf16 v[76:79], v[252:255], v[64:71], v250
    v_exp_f32 v110, v110
    v_exp_f32 v111, v111
    v_cvt_pk_bf16_f32 v62, v108, v109
    v_mfma_f32_32x32x16_bf16 v[144:159], v[52:55], v[68:71], v[144:159]
    s_waitcnt vmcnt(2) lgkmcnt(0)
    s_barrier
    v_cvt_pk_bf16_f32 v63, v110, v111
    v_exp_f32 v112, v112
    v_exp_f32 v113, v113
    v_exp_f32 v114, v114
    v_mfma_f32_32x32x16_bf16 v[96:111], v[32:35], v[8:11], v[160:175]
    ds_read_b128 v[24:27], v241 offset:0
    v_exp_f32 v115, v115
    v_cvt_pk_bf16_f32 v64, v112, v113
    v_exp_f32 v116, v116
    v_exp_f32 v117, v117
    v_cvt_pk_bf16_f32 v65, v114, v115
    v_mfma_f32_32x32x16_bf16 v[96:111], v[36:39], v[12:15], v[96:111]
    ds_read_b128 v[28:31], v241 offset:1024
    v_exp_f32 v118, v118
    v_exp_f32 v119, v119
    v_cvt_pk_bf16_f32 v66, v116, v117
    v_exp_f32 v120, v120
    v_exp_f32 v121, v121
    v_cvt_pk_bf16_f32 v67, v118, v119
    v_mfma_f32_32x32x16_bf16 v[128:143], v[40:43], v[56:59], v[128:143]
    ds_read_b128 v[48:51], v241 offset:55296
    v_exp_f32 v122, v122
    v_exp_f32 v123, v123
    v_cvt_pk_bf16_f32 v68, v120, v121
    v_exp_f32 v124, v124
    v_exp_f32 v125, v125
    v_cvt_pk_bf16_f32 v69, v122, v123
    v_smfmac_f32_16x16x64_bf16 v[72:75], v[252:255], v[56:63], v250
    ds_read_b128 v[52:55], v241 offset:56320
    v_exp_f32 v126, v126
    v_exp_f32 v127, v127
    v_cvt_pk_bf16_f32 v70, v124, v125
    v_mfma_f32_32x32x16_bf16 v[128:143], v[44:47], v[60:63], v[128:143]
    v_cvt_pk_bf16_f32 v71, v126, v127
    v_exp_f32 v96, v96
    v_exp_f32 v97, v97
    v_exp_f32 v98, v98
    v_mfma_f32_32x32x16_bf16 v[112:127], v[32:35], v[16:19], v[176:191]
    s_add_u32 m0, s97, 32768
    s_add_u32 s29, s98, 16384
    v_exp_f32 v99, v99
    v_cvt_pk_bf16_f32 v56, v96, v97
    v_exp_f32 v100, v100
    v_exp_f32 v101, v101
    v_cvt_pk_bf16_f32 v57, v98, v99
    v_mfma_f32_32x32x16_bf16 v[112:127], v[36:39], v[20:23], v[112:127]
    buffer_load_dwordx4 v5, s[12:15], s29 offen sc1 lds
    v_exp_f32 v102, v102
    v_exp_f32 v103, v103
    v_cvt_pk_bf16_f32 v58, v100, v101
    v_exp_f32 v104, v104
    v_exp_f32 v105, v105
    v_cvt_pk_bf16_f32 v59, v102, v103
    v_mfma_f32_32x32x16_bf16 v[144:159], v[40:43], v[64:67], v[144:159]
    buffer_load_dwordx4 v5, s[12:15], s29 offen offset:1024 sc1 lds
    v_exp_f32 v106, v106
    v_exp_f32 v107, v107
    v_cvt_pk_bf16_f32 v60, v104, v105
    v_exp_f32 v108, v108
    v_exp_f32 v109, v109
    v_cvt_pk_bf16_f32 v61, v106, v107
    v_smfmac_f32_16x16x64_bf16 v[76:79], v[252:255], v[64:71], v250
    s_waitcnt lgkmcnt(0)
    v_exp_f32 v110, v110
    v_exp_f32 v111, v111
    v_cvt_pk_bf16_f32 v62, v108, v109
    v_mfma_f32_32x32x16_bf16 v[144:159], v[44:47], v[68:71], v[144:159]
    v_cvt_pk_bf16_f32 v63, v110, v111
    v_exp_f32 v112, v112
    v_exp_f32 v113, v113
    v_exp_f32 v114, v114
    v_mfma_f32_32x32x16_bf16 v[96:111], v[24:27], v[8:11], v[160:175]
    ds_read_b128 v[32:35], v241 offset:4096
    v_exp_f32 v115, v115
    v_cvt_pk_bf16_f32 v64, v112, v113
    v_exp_f32 v116, v116
    v_exp_f32 v117, v117
    v_cvt_pk_bf16_f32 v65, v114, v115
    v_mfma_f32_32x32x16_bf16 v[96:111], v[28:31], v[12:15], v[96:111]
    ds_read_b128 v[36:39], v241 offset:5120
    v_exp_f32 v118, v118
    v_exp_f32 v119, v119
    v_cvt_pk_bf16_f32 v66, v116, v117
    v_exp_f32 v120, v120
    v_exp_f32 v121, v121
    v_cvt_pk_bf16_f32 v67, v118, v119
    v_mfma_f32_32x32x16_bf16 v[128:143], v[48:51], v[56:59], v[128:143]
    ds_read_b128 v[40:43], v241 offset:2048
    v_exp_f32 v122, v122
    v_exp_f32 v123, v123
    v_cvt_pk_bf16_f32 v68, v120, v121
    v_exp_f32 v124, v124
    v_exp_f32 v125, v125
    v_cvt_pk_bf16_f32 v69, v122, v123
    v_smfmac_f32_16x16x64_bf16 v[72:75], v[252:255], v[56:63], v250
    ds_read_b128 v[44:47], v241 offset:3072
    v_exp_f32 v126, v126
    v_exp_f32 v127, v127
    v_cvt_pk_bf16_f32 v70, v124, v125
    v_mfma_f32_32x32x16_bf16 v[128:143], v[52:55], v[60:63], v[128:143]
    v_cvt_pk_bf16_f32 v71, v126, v127
    v_exp_f32 v96, v96
    v_exp_f32 v97, v97
    v_exp_f32 v98, v98
    v_mfma_f32_32x32x16_bf16 v[112:127], v[24:27], v[16:19], v[176:191]
    v_exp_f32 v99, v99
    v_cvt_pk_bf16_f32 v56, v96, v97
    v_exp_f32 v100, v100
    v_exp_f32 v101, v101
    v_cvt_pk_bf16_f32 v57, v98, v99
    v_mfma_f32_32x32x16_bf16 v[112:127], v[28:31], v[20:23], v[112:127]
    v_exp_f32 v102, v102
    v_exp_f32 v103, v103
    v_cvt_pk_bf16_f32 v58, v100, v101
    v_exp_f32 v104, v104
    v_exp_f32 v105, v105
    v_cvt_pk_bf16_f32 v59, v102, v103
    v_mfma_f32_32x32x16_bf16 v[144:159], v[48:51], v[64:67], v[144:159]
    v_exp_f32 v106, v106
    v_exp_f32 v107, v107
    v_cvt_pk_bf16_f32 v60, v104, v105
    v_exp_f32 v108, v108
    v_exp_f32 v109, v109
    v_cvt_pk_bf16_f32 v61, v106, v107
    v_smfmac_f32_16x16x64_bf16 v[76:79], v[252:255], v[64:71], v250
    v_exp_f32 v110, v110
    v_exp_f32 v111, v111
    v_cvt_pk_bf16_f32 v62, v108, v109
    v_mfma_f32_32x32x16_bf16 v[144:159], v[52:55], v[68:71], v[144:159]
    s_waitcnt vmcnt(2) lgkmcnt(0)
    s_barrier
    v_cvt_pk_bf16_f32 v63, v110, v111
    v_exp_f32 v112, v112
    v_exp_f32 v113, v113
    v_exp_f32 v114, v114
    v_mfma_f32_32x32x16_bf16 v[96:111], v[32:35], v[8:11], v[160:175]
    ds_read_b128 v[24:27], v241 offset:16384
    v_exp_f32 v115, v115
    v_cvt_pk_bf16_f32 v64, v112, v113
    v_exp_f32 v116, v116
    v_exp_f32 v117, v117
    v_cvt_pk_bf16_f32 v65, v114, v115
    v_mfma_f32_32x32x16_bf16 v[96:111], v[36:39], v[12:15], v[96:111]
    ds_read_b128 v[28:31], v241 offset:17408
    v_exp_f32 v118, v118
    v_exp_f32 v119, v119
    v_cvt_pk_bf16_f32 v66, v116, v117
    v_exp_f32 v120, v120
    v_exp_f32 v121, v121
    v_cvt_pk_bf16_f32 v67, v118, v119
    v_mfma_f32_32x32x16_bf16 v[128:143], v[40:43], v[56:59], v[128:143]
    ds_read_b128 v[48:51], v241 offset:6144
    v_exp_f32 v122, v122
    v_exp_f32 v123, v123
    v_cvt_pk_bf16_f32 v68, v120, v121
    v_exp_f32 v124, v124
    v_exp_f32 v125, v125
    v_cvt_pk_bf16_f32 v69, v122, v123
    v_smfmac_f32_16x16x64_bf16 v[72:75], v[252:255], v[56:63], v250
    ds_read_b128 v[52:55], v241 offset:7168
    v_exp_f32 v126, v126
    v_exp_f32 v127, v127
    v_cvt_pk_bf16_f32 v70, v124, v125
    v_mfma_f32_32x32x16_bf16 v[128:143], v[44:47], v[60:63], v[128:143]
    v_cvt_pk_bf16_f32 v71, v126, v127
    v_exp_f32 v96, v96
    v_exp_f32 v97, v97
    v_exp_f32 v98, v98
    v_mfma_f32_32x32x16_bf16 v[112:127], v[32:35], v[16:19], v[176:191]
    s_add_u32 m0, s97, 49152
    s_add_u32 s29, s98, 24576
    v_exp_f32 v99, v99
    v_cvt_pk_bf16_f32 v56, v96, v97
    v_exp_f32 v100, v100
    v_exp_f32 v101, v101
    v_cvt_pk_bf16_f32 v57, v98, v99
    v_mfma_f32_32x32x16_bf16 v[112:127], v[36:39], v[20:23], v[112:127]
    buffer_load_dwordx4 v5, s[12:15], s29 offen sc1 lds
    v_exp_f32 v102, v102
    v_exp_f32 v103, v103
    v_cvt_pk_bf16_f32 v58, v100, v101
    v_exp_f32 v104, v104
    v_exp_f32 v105, v105
    v_cvt_pk_bf16_f32 v59, v102, v103
    v_mfma_f32_32x32x16_bf16 v[144:159], v[40:43], v[64:67], v[144:159]
    buffer_load_dwordx4 v5, s[12:15], s29 offen offset:1024 sc1 lds
    v_exp_f32 v106, v106
    v_exp_f32 v107, v107
    v_cvt_pk_bf16_f32 v60, v104, v105
    v_exp_f32 v108, v108
    v_exp_f32 v109, v109
    v_cvt_pk_bf16_f32 v61, v106, v107
    v_smfmac_f32_16x16x64_bf16 v[76:79], v[252:255], v[64:71], v250
    s_waitcnt lgkmcnt(0)
    v_exp_f32 v110, v110
    v_exp_f32 v111, v111
    v_cvt_pk_bf16_f32 v62, v108, v109
    v_mfma_f32_32x32x16_bf16 v[144:159], v[44:47], v[68:71], v[144:159]
    v_cvt_pk_bf16_f32 v63, v110, v111
    v_exp_f32 v112, v112
    v_exp_f32 v113, v113
    v_exp_f32 v114, v114
    v_mfma_f32_32x32x16_bf16 v[96:111], v[24:27], v[8:11], v[160:175]
    ds_read_b128 v[32:35], v241 offset:20480
    v_exp_f32 v115, v115
    v_cvt_pk_bf16_f32 v64, v112, v113
    v_exp_f32 v116, v116
    v_exp_f32 v117, v117
    v_cvt_pk_bf16_f32 v65, v114, v115
    v_mfma_f32_32x32x16_bf16 v[96:111], v[28:31], v[12:15], v[96:111]
    ds_read_b128 v[36:39], v241 offset:21504
    v_exp_f32 v118, v118
    v_exp_f32 v119, v119
    v_cvt_pk_bf16_f32 v66, v116, v117
    v_exp_f32 v120, v120
    v_exp_f32 v121, v121
    v_cvt_pk_bf16_f32 v67, v118, v119
    v_mfma_f32_32x32x16_bf16 v[128:143], v[48:51], v[56:59], v[128:143]
    ds_read_b128 v[40:43], v241 offset:18432
    v_exp_f32 v122, v122
    v_exp_f32 v123, v123
    v_cvt_pk_bf16_f32 v68, v120, v121
    v_exp_f32 v124, v124
    v_exp_f32 v125, v125
    v_cvt_pk_bf16_f32 v69, v122, v123
    v_smfmac_f32_16x16x64_bf16 v[72:75], v[252:255], v[56:63], v250
    ds_read_b128 v[44:47], v241 offset:19456
    v_exp_f32 v126, v126
    v_exp_f32 v127, v127
    v_cvt_pk_bf16_f32 v70, v124, v125
    v_mfma_f32_32x32x16_bf16 v[128:143], v[52:55], v[60:63], v[128:143]
    v_cvt_pk_bf16_f32 v71, v126, v127
    v_exp_f32 v96, v96
    v_exp_f32 v97, v97
    v_exp_f32 v98, v98
    v_mfma_f32_32x32x16_bf16 v[112:127], v[24:27], v[16:19], v[176:191]
    v_exp_f32 v99, v99
    v_cvt_pk_bf16_f32 v56, v96, v97
    v_exp_f32 v100, v100
    v_exp_f32 v101, v101
    v_cvt_pk_bf16_f32 v57, v98, v99
    v_mfma_f32_32x32x16_bf16 v[112:127], v[28:31], v[20:23], v[112:127]
    v_exp_f32 v102, v102
    v_exp_f32 v103, v103
    v_cvt_pk_bf16_f32 v58, v100, v101
    v_exp_f32 v104, v104
    v_exp_f32 v105, v105
    v_cvt_pk_bf16_f32 v59, v102, v103
    v_mfma_f32_32x32x16_bf16 v[144:159], v[48:51], v[64:67], v[144:159]
    v_exp_f32 v106, v106
    v_exp_f32 v107, v107
    v_cvt_pk_bf16_f32 v60, v104, v105
    v_exp_f32 v108, v108
    v_exp_f32 v109, v109
    v_cvt_pk_bf16_f32 v61, v106, v107
    v_smfmac_f32_16x16x64_bf16 v[76:79], v[252:255], v[64:71], v250
    v_exp_f32 v110, v110
    v_exp_f32 v111, v111
    v_cvt_pk_bf16_f32 v62, v108, v109
    v_mfma_f32_32x32x16_bf16 v[144:159], v[52:55], v[68:71], v[144:159]
    s_waitcnt vmcnt(2) lgkmcnt(0)
    s_barrier
    v_cvt_pk_bf16_f32 v63, v110, v111
    v_exp_f32 v112, v112
    v_exp_f32 v113, v113
    v_exp_f32 v114, v114
    v_mfma_f32_32x32x16_bf16 v[96:111], v[32:35], v[8:11], v[160:175]
    ds_read_b128 v[24:27], v241 offset:32768
    v_exp_f32 v115, v115
    v_cvt_pk_bf16_f32 v64, v112, v113
    v_exp_f32 v116, v116
    v_exp_f32 v117, v117
    v_cvt_pk_bf16_f32 v65, v114, v115
    v_mfma_f32_32x32x16_bf16 v[96:111], v[36:39], v[12:15], v[96:111]
    ds_read_b128 v[28:31], v241 offset:33792
    v_exp_f32 v118, v118
    v_exp_f32 v119, v119
    v_cvt_pk_bf16_f32 v66, v116, v117
    v_exp_f32 v120, v120
    v_exp_f32 v121, v121
    v_cvt_pk_bf16_f32 v67, v118, v119
    v_mfma_f32_32x32x16_bf16 v[128:143], v[40:43], v[56:59], v[128:143]
    ds_read_b128 v[48:51], v241 offset:22528
    v_exp_f32 v122, v122
    v_exp_f32 v123, v123
    v_cvt_pk_bf16_f32 v68, v120, v121
    v_exp_f32 v124, v124
    v_exp_f32 v125, v125
    v_cvt_pk_bf16_f32 v69, v122, v123
    v_smfmac_f32_16x16x64_bf16 v[72:75], v[252:255], v[56:63], v250
    ds_read_b128 v[52:55], v241 offset:23552
    v_exp_f32 v126, v126
    v_exp_f32 v127, v127
    v_cvt_pk_bf16_f32 v70, v124, v125
    v_mfma_f32_32x32x16_bf16 v[128:143], v[44:47], v[60:63], v[128:143]
    v_cvt_pk_bf16_f32 v71, v126, v127
    v_exp_f32 v96, v96
    v_exp_f32 v97, v97
    v_exp_f32 v98, v98
    v_mfma_f32_32x32x16_bf16 v[112:127], v[32:35], v[16:19], v[176:191]
    s_add_u32 m0, s97, 0
    s_add_u32 s29, s99, 0
    v_exp_f32 v99, v99
    v_cvt_pk_bf16_f32 v56, v96, v97
    v_exp_f32 v100, v100
    v_exp_f32 v101, v101
    v_cvt_pk_bf16_f32 v57, v98, v99
    v_mfma_f32_32x32x16_bf16 v[112:127], v[36:39], v[20:23], v[112:127]
    buffer_load_dwordx4 v5, s[12:15], s29 offen sc1 lds
    v_exp_f32 v102, v102
    v_exp_f32 v103, v103
    v_cvt_pk_bf16_f32 v58, v100, v101
    v_exp_f32 v104, v104
    v_exp_f32 v105, v105
    v_cvt_pk_bf16_f32 v59, v102, v103
    v_mfma_f32_32x32x16_bf16 v[144:159], v[40:43], v[64:67], v[144:159]
    buffer_load_dwordx4 v5, s[12:15], s29 offen offset:1024 sc1 lds
    v_exp_f32 v106, v106
    v_exp_f32 v107, v107
    v_cvt_pk_bf16_f32 v60, v104, v105
    v_exp_f32 v108, v108
    v_exp_f32 v109, v109
    v_cvt_pk_bf16_f32 v61, v106, v107
    v_smfmac_f32_16x16x64_bf16 v[76:79], v[252:255], v[64:71], v250
    s_waitcnt lgkmcnt(0)
    v_exp_f32 v110, v110
    v_exp_f32 v111, v111
    v_cvt_pk_bf16_f32 v62, v108, v109
    v_mfma_f32_32x32x16_bf16 v[144:159], v[44:47], v[68:71], v[144:159]
    v_cvt_pk_bf16_f32 v63, v110, v111
    v_exp_f32 v112, v112
    v_exp_f32 v113, v113
    v_exp_f32 v114, v114
    v_mfma_f32_32x32x16_bf16 v[96:111], v[24:27], v[8:11], v[160:175]
    ds_read_b128 v[32:35], v241 offset:36864
    v_exp_f32 v115, v115
    v_cvt_pk_bf16_f32 v64, v112, v113
    v_exp_f32 v116, v116
    v_exp_f32 v117, v117
    v_cvt_pk_bf16_f32 v65, v114, v115
    v_mfma_f32_32x32x16_bf16 v[96:111], v[28:31], v[12:15], v[96:111]
    ds_read_b128 v[36:39], v241 offset:37888
    v_exp_f32 v118, v118
    v_exp_f32 v119, v119
    v_cvt_pk_bf16_f32 v66, v116, v117
    v_exp_f32 v120, v120
    v_exp_f32 v121, v121
    v_cvt_pk_bf16_f32 v67, v118, v119
    v_mfma_f32_32x32x16_bf16 v[128:143], v[48:51], v[56:59], v[128:143]
    ds_read_b128 v[40:43], v241 offset:34816
    v_exp_f32 v122, v122
    v_exp_f32 v123, v123
    v_cvt_pk_bf16_f32 v68, v120, v121
    v_exp_f32 v124, v124
    v_exp_f32 v125, v125
    v_cvt_pk_bf16_f32 v69, v122, v123
    v_smfmac_f32_16x16x64_bf16 v[72:75], v[252:255], v[56:63], v250
    ds_read_b128 v[44:47], v241 offset:35840
    v_exp_f32 v126, v126
    v_exp_f32 v127, v127
    v_cvt_pk_bf16_f32 v70, v124, v125
    v_mfma_f32_32x32x16_bf16 v[128:143], v[52:55], v[60:63], v[128:143]
    v_cvt_pk_bf16_f32 v71, v126, v127
    v_exp_f32 v96, v96
    v_exp_f32 v97, v97
    v_exp_f32 v98, v98
    v_mfma_f32_32x32x16_bf16 v[112:127], v[24:27], v[16:19], v[176:191]
    s_mov_b32 s98, s99
    s_add_u32 s99, s24, s19
    v_exp_f32 v99, v99
    v_cvt_pk_bf16_f32 v56, v96, v97
    v_exp_f32 v100, v100
    v_exp_f32 v101, v101
    v_cvt_pk_bf16_f32 v57, v98, v99
    v_mfma_f32_32x32x16_bf16 v[112:127], v[28:31], v[20:23], v[112:127]
    s_and_b32 s99, s99, 7
    s_lshl_b32 s99, s99, 15
    v_exp_f32 v102, v102
    v_exp_f32 v103, v103
    v_cvt_pk_bf16_f32 v58, v100, v101
    v_exp_f32 v104, v104
    v_exp_f32 v105, v105
    v_cvt_pk_bf16_f32 v59, v102, v103
    v_mfma_f32_32x32x16_bf16 v[144:159], v[48:51], v[64:67], v[144:159]
    s_add_u32 s99, s99, s96
    s_add_u32 s19, s19, 1
    v_exp_f32 v106, v106
    v_exp_f32 v107, v107
    v_cvt_pk_bf16_f32 v60, v104, v105
    v_exp_f32 v108, v108
    v_exp_f32 v109, v109
    v_cvt_pk_bf16_f32 v61, v106, v107
    v_smfmac_f32_16x16x64_bf16 v[76:79], v[252:255], v[64:71], v250
    s_add_u32 s32, s32, 1
    v_exp_f32 v110, v110
    v_exp_f32 v111, v111
    v_cvt_pk_bf16_f32 v62, v108, v109
    v_mfma_f32_32x32x16_bf16 v[144:159], v[52:55], v[68:71], v[144:159]
    s_waitcnt vmcnt(2) lgkmcnt(0)
    s_barrier
    s_cmp_lt_u32 s32, 5
    v_cvt_pk_bf16_f32 v63, v110, v111
    s_cbranch_scc1 gated_mix__mha_block__softmax_full_mha__prompt_kernel_loop
    v_exp_f32 v112, v112
    v_exp_f32 v113, v113
    v_exp_f32 v114, v114
    v_mfma_f32_32x32x16_bf16 v[96:111], v[32:35], v[8:11], v[160:175]
    ds_read_b128 v[24:27], v241 offset:49152
    v_exp_f32 v115, v115
    v_cvt_pk_bf16_f32 v64, v112, v113
    v_exp_f32 v116, v116
    v_exp_f32 v117, v117
    v_cvt_pk_bf16_f32 v65, v114, v115
    v_mfma_f32_32x32x16_bf16 v[96:111], v[36:39], v[12:15], v[96:111]
    ds_read_b128 v[28:31], v241 offset:50176
    v_exp_f32 v118, v118
    v_exp_f32 v119, v119
    v_cvt_pk_bf16_f32 v66, v116, v117
    v_exp_f32 v120, v120
    v_exp_f32 v121, v121
    v_cvt_pk_bf16_f32 v67, v118, v119
    v_mfma_f32_32x32x16_bf16 v[128:143], v[40:43], v[56:59], v[128:143]
    ds_read_b128 v[48:51], v241 offset:38912
    v_exp_f32 v122, v122
    v_exp_f32 v123, v123
    v_cvt_pk_bf16_f32 v68, v120, v121
    v_exp_f32 v124, v124
    v_exp_f32 v125, v125
    v_cvt_pk_bf16_f32 v69, v122, v123
    v_smfmac_f32_16x16x64_bf16 v[72:75], v[252:255], v[56:63], v250
    ds_read_b128 v[52:55], v241 offset:39936
    v_exp_f32 v126, v126
    v_exp_f32 v127, v127
    v_cvt_pk_bf16_f32 v70, v124, v125
    v_mfma_f32_32x32x16_bf16 v[128:143], v[44:47], v[60:63], v[128:143]
    v_cvt_pk_bf16_f32 v71, v126, v127
    v_exp_f32 v96, v96
    v_exp_f32 v97, v97
    v_exp_f32 v98, v98
    v_mfma_f32_32x32x16_bf16 v[112:127], v[32:35], v[16:19], v[176:191]
    s_add_u32 m0, s97, 16384
    s_add_u32 s29, s98, 8192
    buffer_load_dwordx4 v5, s[12:15], s29 offen sc1 lds
    v_exp_f32 v99, v99
    v_cvt_pk_bf16_f32 v56, v96, v97
    v_exp_f32 v100, v100
    v_exp_f32 v101, v101
    v_cvt_pk_bf16_f32 v57, v98, v99
    v_mfma_f32_32x32x16_bf16 v[112:127], v[36:39], v[20:23], v[112:127]
    buffer_load_dwordx4 v5, s[12:15], s29 offen offset:1024 sc1 lds
    v_exp_f32 v102, v102
    v_exp_f32 v103, v103
    v_cvt_pk_bf16_f32 v58, v100, v101
    v_exp_f32 v104, v104
    v_exp_f32 v105, v105
    v_cvt_pk_bf16_f32 v59, v102, v103
    v_mfma_f32_32x32x16_bf16 v[144:159], v[40:43], v[64:67], v[144:159]
    s_waitcnt lgkmcnt(0)
    v_exp_f32 v106, v106
    v_exp_f32 v107, v107
    v_cvt_pk_bf16_f32 v60, v104, v105
    v_exp_f32 v108, v108
    v_exp_f32 v109, v109
    v_cvt_pk_bf16_f32 v61, v106, v107
    v_smfmac_f32_16x16x64_bf16 v[76:79], v[252:255], v[64:71], v250
    v_exp_f32 v110, v110
    v_exp_f32 v111, v111
    v_cvt_pk_bf16_f32 v62, v108, v109
    v_mfma_f32_32x32x16_bf16 v[144:159], v[44:47], v[68:71], v[144:159]
    v_cvt_pk_bf16_f32 v63, v110, v111
    v_exp_f32 v112, v112
    v_exp_f32 v113, v113
    v_exp_f32 v114, v114
    v_mfma_f32_32x32x16_bf16 v[96:111], v[24:27], v[8:11], v[160:175]
    ds_read_b128 v[32:35], v241 offset:53248
    v_exp_f32 v115, v115
    v_cvt_pk_bf16_f32 v64, v112, v113
    v_exp_f32 v116, v116
    v_exp_f32 v117, v117
    v_cvt_pk_bf16_f32 v65, v114, v115
    v_mfma_f32_32x32x16_bf16 v[96:111], v[28:31], v[12:15], v[96:111]
    ds_read_b128 v[36:39], v241 offset:54272
    v_exp_f32 v118, v118
    v_exp_f32 v119, v119
    v_cvt_pk_bf16_f32 v66, v116, v117
    v_exp_f32 v120, v120
    v_exp_f32 v121, v121
    v_cvt_pk_bf16_f32 v67, v118, v119
    v_mfma_f32_32x32x16_bf16 v[128:143], v[48:51], v[56:59], v[128:143]
    ds_read_b128 v[40:43], v241 offset:51200
    v_exp_f32 v122, v122
    v_exp_f32 v123, v123
    v_cvt_pk_bf16_f32 v68, v120, v121
    v_exp_f32 v124, v124
    v_exp_f32 v125, v125
    v_cvt_pk_bf16_f32 v69, v122, v123
    v_smfmac_f32_16x16x64_bf16 v[72:75], v[252:255], v[56:63], v250
    ds_read_b128 v[44:47], v241 offset:52224
    v_exp_f32 v126, v126
    v_exp_f32 v127, v127
    v_cvt_pk_bf16_f32 v70, v124, v125
    v_mfma_f32_32x32x16_bf16 v[128:143], v[52:55], v[60:63], v[128:143]
    v_cvt_pk_bf16_f32 v71, v126, v127
    v_exp_f32 v96, v96
    v_exp_f32 v97, v97
    v_exp_f32 v98, v98
    v_mfma_f32_32x32x16_bf16 v[112:127], v[24:27], v[16:19], v[176:191]
    s_add_u32 m0, s61, 131072
    s_add_u32 s29, s60, 0
    buffer_load_dwordx4 v240, s[4:7], s29 offen lds
    v_exp_f32 v99, v99
    v_cvt_pk_bf16_f32 v56, v96, v97
    v_exp_f32 v100, v100
    v_exp_f32 v101, v101
    v_cvt_pk_bf16_f32 v57, v98, v99
    v_mfma_f32_32x32x16_bf16 v[112:127], v[28:31], v[20:23], v[112:127]
    s_add_u32 m0, s61, 132096
    s_add_u32 s29, s60, 16384
    buffer_load_dwordx4 v240, s[4:7], s29 offen lds
    v_exp_f32 v102, v102
    v_exp_f32 v103, v103
    v_cvt_pk_bf16_f32 v58, v100, v101
    v_exp_f32 v104, v104
    v_exp_f32 v105, v105
    v_cvt_pk_bf16_f32 v59, v102, v103
    v_mfma_f32_32x32x16_bf16 v[144:159], v[48:51], v[64:67], v[144:159]
    s_add_u32 s29, s60, 1310720
    buffer_load_dwordx4 v[196:199], v240, s[4:7], s29 offen
    v_exp_f32 v106, v106
    v_exp_f32 v107, v107
    v_cvt_pk_bf16_f32 v60, v104, v105
    v_exp_f32 v108, v108
    v_exp_f32 v109, v109
    v_cvt_pk_bf16_f32 v61, v106, v107
    v_smfmac_f32_16x16x64_bf16 v[76:79], v[252:255], v[64:71], v250
    s_add_u32 s29, s60, 1327104
    buffer_load_dwordx4 v[200:203], v240, s[4:7], s29 offen
    v_exp_f32 v110, v110
    v_exp_f32 v111, v111
    v_cvt_pk_bf16_f32 v62, v108, v109
    v_mfma_f32_32x32x16_bf16 v[144:159], v[52:55], v[68:71], v[144:159]
    s_waitcnt vmcnt(6) lgkmcnt(0)
    s_barrier
    s_add_u32 s29, s60, 1441792
    buffer_load_dwordx4 v[204:207], v240, s[4:7], s29 offen
    v_cvt_pk_bf16_f32 v63, v110, v111
    v_exp_f32 v112, v112
    v_exp_f32 v113, v113
    v_exp_f32 v114, v114
    v_mfma_f32_32x32x16_bf16 v[96:111], v[32:35], v[8:11], v[160:175]
    ds_read_b128 v[24:27], v241 offset:0
    v_exp_f32 v115, v115
    v_cvt_pk_bf16_f32 v64, v112, v113
    v_exp_f32 v116, v116
    v_exp_f32 v117, v117
    v_cvt_pk_bf16_f32 v65, v114, v115
    v_mfma_f32_32x32x16_bf16 v[96:111], v[36:39], v[12:15], v[96:111]
    ds_read_b128 v[28:31], v241 offset:1024
    v_exp_f32 v118, v118
    v_exp_f32 v119, v119
    v_cvt_pk_bf16_f32 v66, v116, v117
    v_exp_f32 v120, v120
    v_exp_f32 v121, v121
    v_cvt_pk_bf16_f32 v67, v118, v119
    v_mfma_f32_32x32x16_bf16 v[128:143], v[40:43], v[56:59], v[128:143]
    ds_read_b128 v[48:51], v241 offset:55296
    v_exp_f32 v122, v122
    v_exp_f32 v123, v123
    v_cvt_pk_bf16_f32 v68, v120, v121
    v_exp_f32 v124, v124
    v_exp_f32 v125, v125
    v_cvt_pk_bf16_f32 v69, v122, v123
    v_smfmac_f32_16x16x64_bf16 v[72:75], v[252:255], v[56:63], v250
    ds_read_b128 v[52:55], v241 offset:56320
    v_exp_f32 v126, v126
    v_exp_f32 v127, v127
    v_cvt_pk_bf16_f32 v70, v124, v125
    v_mfma_f32_32x32x16_bf16 v[128:143], v[44:47], v[60:63], v[128:143]
    v_cvt_pk_bf16_f32 v71, v126, v127
    v_exp_f32 v96, v96
    v_exp_f32 v97, v97
    v_exp_f32 v98, v98
    v_mfma_f32_32x32x16_bf16 v[112:127], v[32:35], v[16:19], v[176:191]
    s_add_u32 m0, s97, 32768
    s_add_u32 s29, s98, 16384
    buffer_load_dwordx4 v5, s[12:15], s29 offen sc1 lds
    v_exp_f32 v99, v99
    v_cvt_pk_bf16_f32 v56, v96, v97
    v_exp_f32 v100, v100
    v_exp_f32 v101, v101
    v_cvt_pk_bf16_f32 v57, v98, v99
    v_mfma_f32_32x32x16_bf16 v[112:127], v[36:39], v[20:23], v[112:127]
    buffer_load_dwordx4 v5, s[12:15], s29 offen offset:1024 sc1 lds
    v_exp_f32 v102, v102
    v_exp_f32 v103, v103
    v_cvt_pk_bf16_f32 v58, v100, v101
    v_exp_f32 v104, v104
    v_exp_f32 v105, v105
    v_cvt_pk_bf16_f32 v59, v102, v103
    v_mfma_f32_32x32x16_bf16 v[144:159], v[40:43], v[64:67], v[144:159]
    s_add_u32 m0, s61, 147456
    s_add_u32 s29, s60, 131072
    buffer_load_dwordx4 v240, s[4:7], s29 offen lds
    v_exp_f32 v106, v106
    v_exp_f32 v107, v107
    v_cvt_pk_bf16_f32 v60, v104, v105
    v_exp_f32 v108, v108
    v_exp_f32 v109, v109
    v_cvt_pk_bf16_f32 v61, v106, v107
    v_smfmac_f32_16x16x64_bf16 v[76:79], v[252:255], v[64:71], v250
    s_add_u32 m0, s61, 148480
    s_add_u32 s29, s60, 147456
    buffer_load_dwordx4 v240, s[4:7], s29 offen lds
    v_exp_f32 v110, v110
    v_exp_f32 v111, v111
    v_cvt_pk_bf16_f32 v62, v108, v109
    v_mfma_f32_32x32x16_bf16 v[144:159], v[44:47], v[68:71], v[144:159]
    s_waitcnt lgkmcnt(0)
    v_cvt_pk_bf16_f32 v63, v110, v111
    v_exp_f32 v112, v112
    v_exp_f32 v113, v113
    v_exp_f32 v114, v114
    v_mfma_f32_32x32x16_bf16 v[96:111], v[24:27], v[8:11], v[160:175]
    ds_read_b128 v[32:35], v241 offset:4096
    v_exp_f32 v115, v115
    v_cvt_pk_bf16_f32 v64, v112, v113
    v_exp_f32 v116, v116
    v_exp_f32 v117, v117
    v_cvt_pk_bf16_f32 v65, v114, v115
    v_mfma_f32_32x32x16_bf16 v[96:111], v[28:31], v[12:15], v[96:111]
    ds_read_b128 v[36:39], v241 offset:5120
    v_exp_f32 v118, v118
    v_exp_f32 v119, v119
    v_cvt_pk_bf16_f32 v66, v116, v117
    v_exp_f32 v120, v120
    v_exp_f32 v121, v121
    v_cvt_pk_bf16_f32 v67, v118, v119
    v_mfma_f32_32x32x16_bf16 v[128:143], v[48:51], v[56:59], v[128:143]
    ds_read_b128 v[40:43], v241 offset:2048
    v_exp_f32 v122, v122
    v_exp_f32 v123, v123
    v_cvt_pk_bf16_f32 v68, v120, v121
    v_exp_f32 v124, v124
    v_exp_f32 v125, v125
    v_cvt_pk_bf16_f32 v69, v122, v123
    v_smfmac_f32_16x16x64_bf16 v[72:75], v[252:255], v[56:63], v250
    ds_read_b128 v[44:47], v241 offset:3072
    v_exp_f32 v126, v126
    v_exp_f32 v127, v127
    v_cvt_pk_bf16_f32 v70, v124, v125
    v_mfma_f32_32x32x16_bf16 v[128:143], v[52:55], v[60:63], v[128:143]
    v_cvt_pk_bf16_f32 v71, v126, v127
    v_exp_f32 v96, v96
    v_exp_f32 v97, v97
    v_exp_f32 v98, v98
    v_mfma_f32_32x32x16_bf16 v[112:127], v[24:27], v[16:19], v[176:191]
    s_add_u32 s29, s60, 1458176
    buffer_load_dwordx4 v[208:211], v240, s[4:7], s29 offen
    v_exp_f32 v99, v99
    v_cvt_pk_bf16_f32 v56, v96, v97
    v_exp_f32 v100, v100
    v_exp_f32 v101, v101
    v_cvt_pk_bf16_f32 v57, v98, v99
    v_mfma_f32_32x32x16_bf16 v[112:127], v[28:31], v[20:23], v[112:127]
    s_add_u32 s29, s60, 1572864
    buffer_load_dwordx4 v[212:215], v240, s[4:7], s29 offen
    v_exp_f32 v102, v102
    v_exp_f32 v103, v103
    v_cvt_pk_bf16_f32 v58, v100, v101
    v_exp_f32 v104, v104
    v_exp_f32 v105, v105
    v_cvt_pk_bf16_f32 v59, v102, v103
    v_mfma_f32_32x32x16_bf16 v[144:159], v[48:51], v[64:67], v[144:159]
    s_add_u32 s29, s60, 1589248
    buffer_load_dwordx4 v[216:219], v240, s[4:7], s29 offen
    v_exp_f32 v106, v106
    v_exp_f32 v107, v107
    v_cvt_pk_bf16_f32 v60, v104, v105
    v_exp_f32 v108, v108
    v_exp_f32 v109, v109
    v_cvt_pk_bf16_f32 v61, v106, v107
    v_smfmac_f32_16x16x64_bf16 v[76:79], v[252:255], v[64:71], v250
    s_add_u32 m0, s61, 0
    s_add_u32 s29, s60, 262144
    buffer_load_dwordx4 v240, s[4:7], s29 offen lds
    v_exp_f32 v110, v110
    v_exp_f32 v111, v111
    v_cvt_pk_bf16_f32 v62, v108, v109
    v_mfma_f32_32x32x16_bf16 v[144:159], v[52:55], v[68:71], v[144:159]
    s_waitcnt vmcnt(13) lgkmcnt(0)
    s_barrier
    s_add_u32 m0, s61, 1024
    s_add_u32 s29, s60, 278528
    buffer_load_dwordx4 v240, s[4:7], s29 offen lds
    v_cvt_pk_bf16_f32 v63, v110, v111
    v_exp_f32 v112, v112
    v_exp_f32 v113, v113
    v_exp_f32 v114, v114
    v_mfma_f32_32x32x16_bf16 v[96:111], v[32:35], v[8:11], v[160:175]
    ds_read_b128 v[24:27], v241 offset:16384
    v_exp_f32 v115, v115
    v_cvt_pk_bf16_f32 v64, v112, v113
    v_exp_f32 v116, v116
    v_exp_f32 v117, v117
    v_cvt_pk_bf16_f32 v65, v114, v115
    v_mfma_f32_32x32x16_bf16 v[96:111], v[36:39], v[12:15], v[96:111]
    ds_read_b128 v[28:31], v241 offset:17408
    v_exp_f32 v118, v118
    v_exp_f32 v119, v119
    v_cvt_pk_bf16_f32 v66, v116, v117
    v_exp_f32 v120, v120
    v_exp_f32 v121, v121
    v_cvt_pk_bf16_f32 v67, v118, v119
    v_mfma_f32_32x32x16_bf16 v[128:143], v[40:43], v[56:59], v[128:143]
    ds_read_b128 v[48:51], v241 offset:6144
    v_exp_f32 v122, v122
    v_exp_f32 v123, v123
    v_cvt_pk_bf16_f32 v68, v120, v121
    v_exp_f32 v124, v124
    v_exp_f32 v125, v125
    v_cvt_pk_bf16_f32 v69, v122, v123
    v_smfmac_f32_16x16x64_bf16 v[72:75], v[252:255], v[56:63], v250
    ds_read_b128 v[52:55], v241 offset:7168
    v_exp_f32 v126, v126
    v_exp_f32 v127, v127
    v_cvt_pk_bf16_f32 v70, v124, v125
    v_mfma_f32_32x32x16_bf16 v[128:143], v[44:47], v[60:63], v[128:143]
    v_cvt_pk_bf16_f32 v71, v126, v127
    v_exp_f32 v96, v96
    v_exp_f32 v97, v97
    v_exp_f32 v98, v98
    v_mfma_f32_32x32x16_bf16 v[112:127], v[32:35], v[16:19], v[176:191]
    s_add_u32 m0, s97, 49152
    s_add_u32 s29, s98, 24576
    buffer_load_dwordx4 v5, s[12:15], s29 offen sc1 lds
    v_exp_f32 v99, v99
    v_cvt_pk_bf16_f32 v56, v96, v97
    v_exp_f32 v100, v100
    v_exp_f32 v101, v101
    v_cvt_pk_bf16_f32 v57, v98, v99
    v_mfma_f32_32x32x16_bf16 v[112:127], v[36:39], v[20:23], v[112:127]
    buffer_load_dwordx4 v5, s[12:15], s29 offen offset:1024 sc1 lds
    v_exp_f32 v102, v102
    v_exp_f32 v103, v103
    v_cvt_pk_bf16_f32 v58, v100, v101
    v_exp_f32 v104, v104
    v_exp_f32 v105, v105
    v_cvt_pk_bf16_f32 v59, v102, v103
    v_mfma_f32_32x32x16_bf16 v[144:159], v[40:43], v[64:67], v[144:159]
    s_add_u32 m0, s61, 16384
    s_add_u32 s29, s60, 393216
    buffer_load_dwordx4 v240, s[4:7], s29 offen lds
    v_exp_f32 v106, v106
    v_exp_f32 v107, v107
    v_cvt_pk_bf16_f32 v60, v104, v105
    v_exp_f32 v108, v108
    v_exp_f32 v109, v109
    v_cvt_pk_bf16_f32 v61, v106, v107
    v_smfmac_f32_16x16x64_bf16 v[76:79], v[252:255], v[64:71], v250
    s_add_u32 m0, s61, 17408
    s_add_u32 s29, s60, 409600
    buffer_load_dwordx4 v240, s[4:7], s29 offen lds
    v_exp_f32 v110, v110
    v_exp_f32 v111, v111
    v_cvt_pk_bf16_f32 v62, v108, v109
    v_mfma_f32_32x32x16_bf16 v[144:159], v[44:47], v[68:71], v[144:159]
    s_waitcnt lgkmcnt(0)
    v_cvt_pk_bf16_f32 v63, v110, v111
    v_exp_f32 v112, v112
    v_exp_f32 v113, v113
    v_exp_f32 v114, v114
    v_mfma_f32_32x32x16_bf16 v[96:111], v[24:27], v[8:11], v[160:175]
    ds_read_b128 v[32:35], v241 offset:20480
    v_exp_f32 v115, v115
    v_cvt_pk_bf16_f32 v64, v112, v113
    v_exp_f32 v116, v116
    v_exp_f32 v117, v117
    v_cvt_pk_bf16_f32 v65, v114, v115
    v_mfma_f32_32x32x16_bf16 v[96:111], v[28:31], v[12:15], v[96:111]
    ds_read_b128 v[36:39], v241 offset:21504
    v_exp_f32 v118, v118
    v_exp_f32 v119, v119
    v_cvt_pk_bf16_f32 v66, v116, v117
    v_exp_f32 v120, v120
    v_exp_f32 v121, v121
    v_cvt_pk_bf16_f32 v67, v118, v119
    v_mfma_f32_32x32x16_bf16 v[128:143], v[48:51], v[56:59], v[128:143]
    ds_read_b128 v[40:43], v241 offset:18432
    v_exp_f32 v122, v122
    v_exp_f32 v123, v123
    v_cvt_pk_bf16_f32 v68, v120, v121
    v_exp_f32 v124, v124
    v_exp_f32 v125, v125
    v_cvt_pk_bf16_f32 v69, v122, v123
    v_smfmac_f32_16x16x64_bf16 v[72:75], v[252:255], v[56:63], v250
    ds_read_b128 v[44:47], v241 offset:19456
    v_exp_f32 v126, v126
    v_exp_f32 v127, v127
    v_cvt_pk_bf16_f32 v70, v124, v125
    v_mfma_f32_32x32x16_bf16 v[128:143], v[52:55], v[60:63], v[128:143]
    v_cvt_pk_bf16_f32 v71, v126, v127
    v_exp_f32 v96, v96
    v_exp_f32 v97, v97
    v_exp_f32 v98, v98
    v_mfma_f32_32x32x16_bf16 v[112:127], v[24:27], v[16:19], v[176:191]
    s_add_u32 s29, s60, 1703936
    buffer_load_dwordx4 v[220:223], v240, s[4:7], s29 offen
    v_exp_f32 v99, v99
    v_cvt_pk_bf16_f32 v56, v96, v97
    v_exp_f32 v100, v100
    v_exp_f32 v101, v101
    v_cvt_pk_bf16_f32 v57, v98, v99
    v_mfma_f32_32x32x16_bf16 v[112:127], v[28:31], v[20:23], v[112:127]
    s_add_u32 s29, s60, 1720320
    buffer_load_dwordx4 v[224:227], v240, s[4:7], s29 offen
    v_exp_f32 v102, v102
    v_exp_f32 v103, v103
    v_cvt_pk_bf16_f32 v58, v100, v101
    v_exp_f32 v104, v104
    v_exp_f32 v105, v105
    v_cvt_pk_bf16_f32 v59, v102, v103
    v_mfma_f32_32x32x16_bf16 v[144:159], v[48:51], v[64:67], v[144:159]
    s_add_u32 s29, s60, 1835008
    buffer_load_dwordx4 v[228:231], v240, s[4:7], s29 offen
    v_exp_f32 v106, v106
    v_exp_f32 v107, v107
    v_cvt_pk_bf16_f32 v60, v104, v105
    v_exp_f32 v108, v108
    v_exp_f32 v109, v109
    v_cvt_pk_bf16_f32 v61, v106, v107
    v_smfmac_f32_16x16x64_bf16 v[76:79], v[252:255], v[64:71], v250
    s_add_u32 m0, s61, 32768
    s_add_u32 s29, s60, 524288
    buffer_load_dwordx4 v240, s[4:7], s29 offen lds
    v_exp_f32 v110, v110
    v_exp_f32 v111, v111
    v_cvt_pk_bf16_f32 v62, v108, v109
    v_mfma_f32_32x32x16_bf16 v[144:159], v[52:55], v[68:71], v[144:159]
    s_waitcnt vmcnt(15) lgkmcnt(0)
    s_barrier
    s_add_u32 m0, s61, 33792
    s_add_u32 s29, s60, 540672
    buffer_load_dwordx4 v240, s[4:7], s29 offen lds
    v_cvt_pk_bf16_f32 v63, v110, v111
    v_exp_f32 v112, v112
    v_exp_f32 v113, v113
    v_exp_f32 v114, v114
    v_mfma_f32_32x32x16_bf16 v[96:111], v[32:35], v[8:11], v[160:175]
    ds_read_b128 v[24:27], v241 offset:32768
    v_exp_f32 v115, v115
    v_cvt_pk_bf16_f32 v64, v112, v113
    v_exp_f32 v116, v116
    v_exp_f32 v117, v117
    v_cvt_pk_bf16_f32 v65, v114, v115
    v_mfma_f32_32x32x16_bf16 v[96:111], v[36:39], v[12:15], v[96:111]
    ds_read_b128 v[28:31], v241 offset:33792
    v_exp_f32 v118, v118
    v_exp_f32 v119, v119
    v_cvt_pk_bf16_f32 v66, v116, v117
    v_exp_f32 v120, v120
    v_exp_f32 v121, v121
    v_cvt_pk_bf16_f32 v67, v118, v119
    v_mfma_f32_32x32x16_bf16 v[128:143], v[40:43], v[56:59], v[128:143]
    ds_read_b128 v[48:51], v241 offset:22528
    v_exp_f32 v122, v122
    v_exp_f32 v123, v123
    v_cvt_pk_bf16_f32 v68, v120, v121
    v_exp_f32 v124, v124
    v_exp_f32 v125, v125
    v_cvt_pk_bf16_f32 v69, v122, v123
    v_smfmac_f32_16x16x64_bf16 v[72:75], v[252:255], v[56:63], v250
    ds_read_b128 v[52:55], v241 offset:23552
    v_exp_f32 v126, v126
    v_exp_f32 v127, v127
    v_cvt_pk_bf16_f32 v70, v124, v125
    v_mfma_f32_32x32x16_bf16 v[128:143], v[44:47], v[60:63], v[128:143]
    v_cvt_pk_bf16_f32 v71, v126, v127
    v_exp_f32 v96, v96
    v_exp_f32 v97, v97
    v_exp_f32 v98, v98
    v_mfma_f32_32x32x16_bf16 v[112:127], v[32:35], v[16:19], v[176:191]
    s_add_u32 m0, s61, 49152
    s_add_u32 s29, s60, 655360
    buffer_load_dwordx4 v240, s[4:7], s29 offen lds
    v_exp_f32 v99, v99
    v_cvt_pk_bf16_f32 v56, v96, v97
    v_exp_f32 v100, v100
    v_exp_f32 v101, v101
    v_cvt_pk_bf16_f32 v57, v98, v99
    v_mfma_f32_32x32x16_bf16 v[112:127], v[36:39], v[20:23], v[112:127]
    s_add_u32 m0, s61, 50176
    s_add_u32 s29, s60, 671744
    buffer_load_dwordx4 v240, s[4:7], s29 offen lds
    v_exp_f32 v102, v102
    v_exp_f32 v103, v103
    v_cvt_pk_bf16_f32 v58, v100, v101
    v_exp_f32 v104, v104
    v_exp_f32 v105, v105
    v_cvt_pk_bf16_f32 v59, v102, v103
    v_mfma_f32_32x32x16_bf16 v[144:159], v[40:43], v[64:67], v[144:159]
    s_add_u32 m0, s61, 65536
    s_add_u32 s29, s60, 786432
    buffer_load_dwordx4 v240, s[4:7], s29 offen lds
    v_exp_f32 v106, v106
    v_exp_f32 v107, v107
    v_cvt_pk_bf16_f32 v60, v104, v105
    v_exp_f32 v108, v108
    v_exp_f32 v109, v109
    v_cvt_pk_bf16_f32 v61, v106, v107
    v_smfmac_f32_16x16x64_bf16 v[76:79], v[252:255], v[64:71], v250
    s_add_u32 m0, s61, 66560
    s_add_u32 s29, s60, 802816
    buffer_load_dwordx4 v240, s[4:7], s29 offen lds
    v_exp_f32 v110, v110
    v_exp_f32 v111, v111
    v_cvt_pk_bf16_f32 v62, v108, v109
    v_mfma_f32_32x32x16_bf16 v[144:159], v[44:47], v[68:71], v[144:159]
    s_waitcnt lgkmcnt(0)
    v_cvt_pk_bf16_f32 v63, v110, v111
    v_exp_f32 v112, v112
    v_exp_f32 v113, v113
    v_exp_f32 v114, v114
    v_mfma_f32_32x32x16_bf16 v[96:111], v[24:27], v[8:11], v[160:175]
    ds_read_b128 v[32:35], v241 offset:36864
    v_exp_f32 v115, v115
    v_cvt_pk_bf16_f32 v64, v112, v113
    v_exp_f32 v116, v116
    v_exp_f32 v117, v117
    v_cvt_pk_bf16_f32 v65, v114, v115
    v_mfma_f32_32x32x16_bf16 v[96:111], v[28:31], v[12:15], v[96:111]
    ds_read_b128 v[36:39], v241 offset:37888
    v_exp_f32 v118, v118
    v_exp_f32 v119, v119
    v_cvt_pk_bf16_f32 v66, v116, v117
    v_exp_f32 v120, v120
    v_exp_f32 v121, v121
    v_cvt_pk_bf16_f32 v67, v118, v119
    v_mfma_f32_32x32x16_bf16 v[128:143], v[48:51], v[56:59], v[128:143]
    ds_read_b128 v[40:43], v241 offset:34816
    v_exp_f32 v122, v122
    v_exp_f32 v123, v123
    v_cvt_pk_bf16_f32 v68, v120, v121
    v_exp_f32 v124, v124
    v_exp_f32 v125, v125
    v_cvt_pk_bf16_f32 v69, v122, v123
    v_smfmac_f32_16x16x64_bf16 v[72:75], v[252:255], v[56:63], v250
    ds_read_b128 v[44:47], v241 offset:35840
    v_exp_f32 v126, v126
    v_exp_f32 v127, v127
    v_cvt_pk_bf16_f32 v70, v124, v125
    v_mfma_f32_32x32x16_bf16 v[128:143], v[52:55], v[60:63], v[128:143]
    v_cvt_pk_bf16_f32 v71, v126, v127
    v_exp_f32 v96, v96
    v_exp_f32 v97, v97
    v_exp_f32 v98, v98
    v_mfma_f32_32x32x16_bf16 v[112:127], v[24:27], v[16:19], v[176:191]
    s_add_u32 s29, s60, 1851392
    buffer_load_dwordx4 v[232:235], v240, s[4:7], s29 offen
    v_exp_f32 v99, v99
    v_cvt_pk_bf16_f32 v56, v96, v97
    v_exp_f32 v100, v100
    v_exp_f32 v101, v101
    v_cvt_pk_bf16_f32 v57, v98, v99
    v_mfma_f32_32x32x16_bf16 v[112:127], v[28:31], v[20:23], v[112:127]
    s_add_u32 s29, s60, 1966080
    buffer_load_dwordx4 v[236:239], v240, s[4:7], s29 offen
    v_exp_f32 v102, v102
    v_exp_f32 v103, v103
    v_cvt_pk_bf16_f32 v58, v100, v101
    v_exp_f32 v104, v104
    v_exp_f32 v105, v105
    v_cvt_pk_bf16_f32 v59, v102, v103
    v_mfma_f32_32x32x16_bf16 v[144:159], v[48:51], v[64:67], v[144:159]
    s_add_u32 s29, s60, 1982464
    buffer_load_dwordx4 v[84:87], v240, s[4:7], s29 offen
    v_exp_f32 v106, v106
    v_exp_f32 v107, v107
    v_cvt_pk_bf16_f32 v60, v104, v105
    v_exp_f32 v108, v108
    v_exp_f32 v109, v109
    v_cvt_pk_bf16_f32 v61, v106, v107
    v_smfmac_f32_16x16x64_bf16 v[76:79], v[252:255], v[64:71], v250
    v_exp_f32 v110, v110
    v_exp_f32 v111, v111
    v_cvt_pk_bf16_f32 v62, v108, v109
    v_mfma_f32_32x32x16_bf16 v[144:159], v[52:55], v[68:71], v[144:159]
    s_waitcnt vmcnt(14) lgkmcnt(0)
    s_barrier
    v_cvt_pk_bf16_f32 v63, v110, v111
    v_exp_f32 v112, v112
    v_exp_f32 v113, v113
    v_exp_f32 v114, v114
    v_mfma_f32_32x32x16_bf16 v[96:111], v[32:35], v[8:11], v[160:175]
    ds_read_b128 v[24:27], v241 offset:49152
    v_exp_f32 v115, v115
    v_cvt_pk_bf16_f32 v64, v112, v113
    v_exp_f32 v116, v116
    v_exp_f32 v117, v117
    v_cvt_pk_bf16_f32 v65, v114, v115
    v_mfma_f32_32x32x16_bf16 v[96:111], v[36:39], v[12:15], v[96:111]
    ds_read_b128 v[28:31], v241 offset:50176
    v_exp_f32 v118, v118
    v_exp_f32 v119, v119
    v_cvt_pk_bf16_f32 v66, v116, v117
    v_exp_f32 v120, v120
    v_exp_f32 v121, v121
    v_cvt_pk_bf16_f32 v67, v118, v119
    v_mfma_f32_32x32x16_bf16 v[128:143], v[40:43], v[56:59], v[128:143]
    ds_read_b128 v[48:51], v241 offset:38912
    v_exp_f32 v122, v122
    v_exp_f32 v123, v123
    v_cvt_pk_bf16_f32 v68, v120, v121
    v_exp_f32 v124, v124
    v_exp_f32 v125, v125
    v_cvt_pk_bf16_f32 v69, v122, v123
    v_smfmac_f32_16x16x64_bf16 v[72:75], v[252:255], v[56:63], v250
    ds_read_b128 v[52:55], v241 offset:39936
    v_exp_f32 v126, v126
    v_exp_f32 v127, v127
    v_cvt_pk_bf16_f32 v70, v124, v125
    v_mfma_f32_32x32x16_bf16 v[128:143], v[44:47], v[60:63], v[128:143]
    v_cvt_pk_bf16_f32 v71, v126, v127
    v_exp_f32 v96, v96
    v_exp_f32 v97, v97
    v_exp_f32 v98, v98
    v_mfma_f32_32x32x16_bf16 v[112:127], v[32:35], v[16:19], v[176:191]
    s_add_u32 m0, s61, 81920
    s_add_u32 s29, s60, 917504
    buffer_load_dwordx4 v240, s[4:7], s29 offen lds
    v_exp_f32 v99, v99
    v_cvt_pk_bf16_f32 v56, v96, v97
    v_exp_f32 v100, v100
    v_exp_f32 v101, v101
    v_cvt_pk_bf16_f32 v57, v98, v99
    v_mfma_f32_32x32x16_bf16 v[112:127], v[36:39], v[20:23], v[112:127]
    s_add_u32 m0, s61, 82944
    s_add_u32 s29, s60, 933888
    buffer_load_dwordx4 v240, s[4:7], s29 offen lds
    v_exp_f32 v102, v102
    v_exp_f32 v103, v103
    v_cvt_pk_bf16_f32 v58, v100, v101
    v_exp_f32 v104, v104
    v_exp_f32 v105, v105
    v_cvt_pk_bf16_f32 v59, v102, v103
    v_mfma_f32_32x32x16_bf16 v[144:159], v[40:43], v[64:67], v[144:159]
    s_waitcnt lgkmcnt(0)
    v_exp_f32 v106, v106
    v_exp_f32 v107, v107
    v_cvt_pk_bf16_f32 v60, v104, v105
    v_exp_f32 v108, v108
    v_exp_f32 v109, v109
    v_cvt_pk_bf16_f32 v61, v106, v107
    v_smfmac_f32_16x16x64_bf16 v[76:79], v[252:255], v[64:71], v250
    v_exp_f32 v110, v110
    v_exp_f32 v111, v111
    v_cvt_pk_bf16_f32 v62, v108, v109
    v_mfma_f32_32x32x16_bf16 v[144:159], v[44:47], v[68:71], v[144:159]
    v_cvt_pk_bf16_f32 v63, v110, v111
    v_exp_f32 v112, v112
    v_exp_f32 v113, v113
    v_exp_f32 v114, v114
    v_mfma_f32_32x32x16_bf16 v[96:111], v[24:27], v[8:11], v[160:175]
    ds_read_b128 v[32:35], v241 offset:53248
    v_exp_f32 v115, v115
    v_cvt_pk_bf16_f32 v64, v112, v113
    v_exp_f32 v116, v116
    v_exp_f32 v117, v117
    v_cvt_pk_bf16_f32 v65, v114, v115
    v_mfma_f32_32x32x16_bf16 v[96:111], v[28:31], v[12:15], v[96:111]
    ds_read_b128 v[36:39], v241 offset:54272
    v_exp_f32 v118, v118
    v_exp_f32 v119, v119
    v_cvt_pk_bf16_f32 v66, v116, v117
    v_exp_f32 v120, v120
    v_exp_f32 v121, v121
    v_cvt_pk_bf16_f32 v67, v118, v119
    v_mfma_f32_32x32x16_bf16 v[128:143], v[48:51], v[56:59], v[128:143]
    ds_read_b128 v[40:43], v241 offset:51200
    v_exp_f32 v122, v122
    v_exp_f32 v123, v123
    v_cvt_pk_bf16_f32 v68, v120, v121
    v_exp_f32 v124, v124
    v_exp_f32 v125, v125
    v_cvt_pk_bf16_f32 v69, v122, v123
    v_smfmac_f32_16x16x64_bf16 v[72:75], v[252:255], v[56:63], v250
    ds_read_b128 v[44:47], v241 offset:52224
    v_exp_f32 v126, v126
    v_exp_f32 v127, v127
    v_cvt_pk_bf16_f32 v70, v124, v125
    v_mfma_f32_32x32x16_bf16 v[128:143], v[52:55], v[60:63], v[128:143]
    v_cvt_pk_bf16_f32 v71, v126, v127
    v_exp_f32 v96, v96
    v_exp_f32 v97, v97
    v_exp_f32 v98, v98
    v_mfma_f32_32x32x16_bf16 v[112:127], v[24:27], v[16:19], v[176:191]
    v_exp_f32 v99, v99
    v_cvt_pk_bf16_f32 v56, v96, v97
    v_exp_f32 v100, v100
    v_exp_f32 v101, v101
    v_cvt_pk_bf16_f32 v57, v98, v99
    v_mfma_f32_32x32x16_bf16 v[112:127], v[28:31], v[20:23], v[112:127]
    v_exp_f32 v102, v102
    v_exp_f32 v103, v103
    v_cvt_pk_bf16_f32 v58, v100, v101
    v_exp_f32 v104, v104
    v_exp_f32 v105, v105
    v_cvt_pk_bf16_f32 v59, v102, v103
    v_mfma_f32_32x32x16_bf16 v[144:159], v[48:51], v[64:67], v[144:159]
    v_exp_f32 v106, v106
    v_exp_f32 v107, v107
    v_cvt_pk_bf16_f32 v60, v104, v105
    v_exp_f32 v108, v108
    v_exp_f32 v109, v109
    v_cvt_pk_bf16_f32 v61, v106, v107
    v_smfmac_f32_16x16x64_bf16 v[76:79], v[252:255], v[64:71], v250
    v_exp_f32 v110, v110
    v_exp_f32 v111, v111
    v_cvt_pk_bf16_f32 v62, v108, v109
    v_mfma_f32_32x32x16_bf16 v[144:159], v[52:55], v[68:71], v[144:159]
    v_cvt_pk_bf16_f32 v63, v110, v111
    s_waitcnt lgkmcnt(0)
    v_exp_f32 v112, v112
    v_exp_f32 v113, v113
    v_exp_f32 v114, v114
    v_mfma_f32_32x32x16_bf16 v[96:111], v[32:35], v[8:11], v[160:175]
    ds_read_b128 v[48:51], v241 offset:55296
    v_exp_f32 v115, v115
    v_cvt_pk_bf16_f32 v64, v112, v113
    v_exp_f32 v116, v116
    v_exp_f32 v117, v117
    v_cvt_pk_bf16_f32 v65, v114, v115
    v_mfma_f32_32x32x16_bf16 v[96:111], v[36:39], v[12:15], v[96:111]
    ds_read_b128 v[52:55], v241 offset:56320
    v_exp_f32 v118, v118
    v_exp_f32 v119, v119
    v_cvt_pk_bf16_f32 v66, v116, v117
    v_exp_f32 v120, v120
    v_exp_f32 v121, v121
    v_cvt_pk_bf16_f32 v67, v118, v119
    v_mfma_f32_32x32x16_bf16 v[128:143], v[40:43], v[56:59], v[128:143]
    v_exp_f32 v122, v122
    v_exp_f32 v123, v123
    v_cvt_pk_bf16_f32 v68, v120, v121
    v_exp_f32 v124, v124
    v_exp_f32 v125, v125
    v_cvt_pk_bf16_f32 v69, v122, v123
    v_smfmac_f32_16x16x64_bf16 v[72:75], v[252:255], v[56:63], v250
    v_exp_f32 v126, v126
    v_exp_f32 v127, v127
    v_cvt_pk_bf16_f32 v70, v124, v125
    v_mfma_f32_32x32x16_bf16 v[128:143], v[44:47], v[60:63], v[128:143]
    v_cvt_pk_bf16_f32 v71, v126, v127
    v_exp_f32 v96, v96
    v_exp_f32 v97, v97
    v_exp_f32 v98, v98
    v_mfma_f32_32x32x16_bf16 v[112:127], v[32:35], v[16:19], v[176:191]
    v_exp_f32 v99, v99
    v_cvt_pk_bf16_f32 v56, v96, v97
    v_exp_f32 v100, v100
    v_exp_f32 v101, v101
    v_cvt_pk_bf16_f32 v57, v98, v99
    v_mfma_f32_32x32x16_bf16 v[112:127], v[36:39], v[20:23], v[112:127]
    v_exp_f32 v102, v102
    v_exp_f32 v103, v103
    v_cvt_pk_bf16_f32 v58, v100, v101
    v_exp_f32 v104, v104
    v_exp_f32 v105, v105
    v_cvt_pk_bf16_f32 v59, v102, v103
    v_mfma_f32_32x32x16_bf16 v[144:159], v[40:43], v[64:67], v[144:159]
    v_exp_f32 v106, v106
    v_exp_f32 v107, v107
    v_cvt_pk_bf16_f32 v60, v104, v105
    v_exp_f32 v108, v108
    v_exp_f32 v109, v109
    v_cvt_pk_bf16_f32 v61, v106, v107
    v_smfmac_f32_16x16x64_bf16 v[76:79], v[252:255], v[64:71], v250
    v_exp_f32 v110, v110
    v_exp_f32 v111, v111
    v_cvt_pk_bf16_f32 v62, v108, v109
    v_mfma_f32_32x32x16_bf16 v[144:159], v[44:47], v[68:71], v[144:159]
    v_cvt_pk_bf16_f32 v63, v110, v111
    s_waitcnt lgkmcnt(0)
    v_exp_f32 v112, v112
    v_exp_f32 v113, v113
    v_exp_f32 v114, v114
    v_exp_f32 v115, v115
    v_cvt_pk_bf16_f32 v64, v112, v113
    v_exp_f32 v116, v116
    v_exp_f32 v117, v117
    v_cvt_pk_bf16_f32 v65, v114, v115
    v_exp_f32 v118, v118
    v_exp_f32 v119, v119
    v_cvt_pk_bf16_f32 v66, v116, v117
    v_exp_f32 v120, v120
    v_exp_f32 v121, v121
    v_cvt_pk_bf16_f32 v67, v118, v119
    v_mfma_f32_32x32x16_bf16 v[128:143], v[48:51], v[56:59], v[128:143]
    v_exp_f32 v122, v122
    v_exp_f32 v123, v123
    v_cvt_pk_bf16_f32 v68, v120, v121
    v_exp_f32 v124, v124
    v_exp_f32 v125, v125
    v_cvt_pk_bf16_f32 v69, v122, v123
    v_smfmac_f32_16x16x64_bf16 v[72:75], v[252:255], v[56:63], v250
    v_exp_f32 v126, v126
    v_exp_f32 v127, v127
    v_cvt_pk_bf16_f32 v70, v124, v125
    v_mfma_f32_32x32x16_bf16 v[128:143], v[52:55], v[60:63], v[128:143]
    v_cvt_pk_bf16_f32 v71, v126, v127
    s_nop 1
    v_mfma_f32_32x32x16_bf16 v[144:159], v[48:51], v[64:67], v[144:159]
    v_smfmac_f32_16x16x64_bf16 v[76:79], v[252:255], v[64:71], v250
    v_mfma_f32_32x32x16_bf16 v[144:159], v[52:55], v[68:71], v[144:159]
    s_nop 7
    s_nop 3
    s_nop 7
    v_add_f32 v72, v72, v73
    v_add_f32 v76, v76, v77
    v_rcp_f32 v192, v72
    v_rcp_f32 v194, v76
    s_nop 0
    v_mov_b32 v193, v192
    v_mov_b32 v195, v194
    v_pk_mul_f32 v[128:129], v[128:129], v[192:193]
    v_pk_mul_f32 v[130:131], v[130:131], v[192:193]
    v_pk_mul_f32 v[132:133], v[132:133], v[192:193]
    v_pk_mul_f32 v[134:135], v[134:135], v[192:193]
    v_pk_mul_f32 v[136:137], v[136:137], v[192:193]
    v_pk_mul_f32 v[138:139], v[138:139], v[192:193]
    v_pk_mul_f32 v[140:141], v[140:141], v[192:193]
    v_pk_mul_f32 v[142:143], v[142:143], v[192:193]
    v_pk_mul_f32 v[144:145], v[144:145], v[194:195]
    v_pk_mul_f32 v[146:147], v[146:147], v[194:195]
    v_pk_mul_f32 v[148:149], v[148:149], v[194:195]
    v_pk_mul_f32 v[150:151], v[150:151], v[194:195]
    v_pk_mul_f32 v[152:153], v[152:153], v[194:195]
    v_pk_mul_f32 v[154:155], v[154:155], v[194:195]
    v_pk_mul_f32 v[156:157], v[156:157], v[194:195]
    v_pk_mul_f32 v[158:159], v[158:159], v[194:195]
    v_mov_b32 v88, 0
    v_mov_b32 v89, 0
    v_mov_b32 v90, 0
    v_mov_b32 v91, 0
    v_pk_fma_f32 v[90:91], v[128:129], v[88:89], v[90:91]
    v_pk_fma_f32 v[90:91], v[130:131], v[88:89], v[90:91]
    v_pk_fma_f32 v[90:91], v[132:133], v[88:89], v[90:91]
    v_pk_fma_f32 v[90:91], v[134:135], v[88:89], v[90:91]
    v_pk_fma_f32 v[90:91], v[136:137], v[88:89], v[90:91]
    v_pk_fma_f32 v[90:91], v[138:139], v[88:89], v[90:91]
    v_pk_fma_f32 v[90:91], v[140:141], v[88:89], v[90:91]
    v_pk_fma_f32 v[90:91], v[142:143], v[88:89], v[90:91]
    v_pk_fma_f32 v[90:91], v[144:145], v[88:89], v[90:91]
    v_pk_fma_f32 v[90:91], v[146:147], v[88:89], v[90:91]
    v_pk_fma_f32 v[90:91], v[148:149], v[88:89], v[90:91]
    v_pk_fma_f32 v[90:91], v[150:151], v[88:89], v[90:91]
    v_pk_fma_f32 v[90:91], v[152:153], v[88:89], v[90:91]
    v_pk_fma_f32 v[90:91], v[154:155], v[88:89], v[90:91]
    v_pk_fma_f32 v[90:91], v[156:157], v[88:89], v[90:91]
    v_pk_fma_f32 v[90:91], v[158:159], v[88:89], v[90:91]
    v_add_f32 v193, v90, v91
    s_mov_b32 s28, 0x71800000
    v_cmp_nle_f32 vcc, v72, s28
    v_cmp_nle_f32 s[16:17], v76, s28
    v_cmp_u_f32 s[18:19], v193, v193
    s_or_b64 vcc, vcc, s[16:17]
    s_or_b64 vcc, vcc, s[18:19]
    s_cbranch_vccnz gated_mix__mha_block__softmax_full_mha__prompt_kernel_fallback
gated_mix__mha_block__softmax_full_mha__prompt_kernel_store_o:
    s_lshl_b32 s28, s24, 3
    s_lshl_b32 s29, s21, 1
    s_add_u32 s28, s28, s29
    s_lshl_b32 s28, s28, 17
    s_lshl_b32 s29, s27, 11
    s_add_u32 s28, s28, s29
    s_add_u32 s33, s28, 25165824
    v_cvt_pk_bf16_f32 v56, v128, v129
    v_cvt_pk_bf16_f32 v57, v130, v131
    v_cvt_pk_bf16_f32 v58, v132, v133
    v_cvt_pk_bf16_f32 v59, v134, v135
    v_cvt_pk_bf16_f32 v60, v136, v137
    v_cvt_pk_bf16_f32 v61, v138, v139
    v_cvt_pk_bf16_f32 v62, v140, v141
    v_cvt_pk_bf16_f32 v63, v142, v143
    s_add_u32 s28, s33, 0
    buffer_store_dwordx4 v[56:59], v5, s[12:15], s28 offen offset:0 sc1
    buffer_store_dwordx4 v[60:63], v5, s[12:15], s28 offen offset:1024 sc1
    v_cvt_pk_bf16_f32 v64, v144, v145
    v_cvt_pk_bf16_f32 v65, v146, v147
    v_cvt_pk_bf16_f32 v66, v148, v149
    v_cvt_pk_bf16_f32 v67, v150, v151
    v_cvt_pk_bf16_f32 v68, v152, v153
    v_cvt_pk_bf16_f32 v69, v154, v155
    v_cvt_pk_bf16_f32 v70, v156, v157
    v_cvt_pk_bf16_f32 v71, v158, v159
    s_add_u32 s28, s33, 131072
    buffer_store_dwordx4 v[64:67], v5, s[12:15], s28 offen offset:0 sc1
    buffer_store_dwordx4 v[68:71], v5, s[12:15], s28 offen offset:1024 sc1
    v_and_b32 v2, 15, v1
    v_lshrrev_b32 v3, 5, v1
    v_lshlrev_b32 v3, 2, v3
    v_lshrrev_b32 v4, 2, v2
    v_add_u32 v3, v3, v4
    v_lshlrev_b32 v8, 7, v3
    v_lshrrev_b32 v3, 3, v2
    v_lshl_add_u32 v8, v3, 6, v8
    v_bfe_u32 v3, v1, 4, 1
    v_lshl_add_u32 v8, v3, 5, v8
    v_and_b32 v3, 3, v2
    v_lshl_add_u32 v8, v3, 3, v8
    s_lshl_b32 s28, s22, 13
    v_add_u32 v8, s28, v8
    v_xor_b32 v9, 64, v8
    v_add_u32 v10, 65536, v8
    v_add_u32 v11, 65536, v9
    v_add_u32 v12, 131072, v8
    v_add_u32 v13, 131072, v9
    s_lshl_b32 s28, s62, 2
    s_add_u32 s28, s28, s21
    s_lshl_b32 s30, s28, 17
    s_lshl_b32 s29, s22, 16
    s_add_u32 s30, s30, s29
    s_add_u32 s30, s30, 25165824
    s_lshl_b32 s28, s24, 10
    s_add_u32 s28, s28, 34611200
    v_lshlrev_b32 v14, 8, v1
    v_add_u32 v14, s28, v14
    s_lshl_b32 s28, s47, 2
    s_bfe_u32 s29, s2, 0x20005
    s_add_u32 s28, s28, s29
    s_lshl_b32 s28, s28, 8
    s_add_u32 s28, s28, 34611200
    v_mov_b32 v15, s28
    s_waitcnt vmcnt(0)
    s_barrier
    s_cmp_lg_u32 s20, 0
    s_cbranch_scc0 gated_mix__mha_block__softmax_full_mha__prompt_kernel_w89
    s_add_u32 m0, s61, 98304
    s_add_u32 s29, s60, 1048576
    buffer_load_dwordx4 v240, s[4:7], s29 offen lds
    s_add_u32 m0, s61, 99328
    s_add_u32 s29, s60, 1064960
    buffer_load_dwordx4 v240, s[4:7], s29 offen lds
    s_add_u32 m0, s61, 114688
    s_add_u32 s29, s60, 1179648
    buffer_load_dwordx4 v240, s[4:7], s29 offen lds
    s_add_u32 m0, s61, 115712
    s_add_u32 s29, s60, 1196032
    buffer_load_dwordx4 v240, s[4:7], s29 offen lds
gated_mix__mha_block__softmax_full_mha__prompt_kernel_w89:
    s_cmp_eq_u32 s20, 0
    s_cbranch_scc0 gated_mix__mha_block__softmax_full_mha__prompt_kernel_sig2
    v_mov_b32 v3, 1
    v_cmp_gt_u32 vcc, 4, v1
    s_and_saveexec_b64 s[16:17], vcc
    buffer_atomic_add v3, v14, s[12:15], 0 offen sc1
    s_mov_b64 exec, s[16:17]
    buffer_load_dword v244, v15, s[12:15], 0 offen sc1
    s_waitcnt vmcnt(0)
    s_mov_b32 s18, 6000
gated_mix__mha_block__softmax_full_mha__prompt_kernel_spin2_l:
    v_readfirstlane_b32 s28, v244
    s_nop 0
    s_cmp_ge_u32 s28, 32
    s_cbranch_scc1 gated_mix__mha_block__softmax_full_mha__prompt_kernel_spin2_ok
gated_mix__mha_block__softmax_full_mha__prompt_kernel_spin2_re:
    s_sub_u32 s18, s18, 1
    s_cmp_eq_u32 s18, 0
    s_cbranch_scc1 gated_mix__mha_block__softmax_full_mha__prompt_kernel_spin2_ok
    buffer_load_dword v244, v15, s[12:15], 0 offen sc1
    s_waitcnt vmcnt(0)
    s_branch gated_mix__mha_block__softmax_full_mha__prompt_kernel_spin2_l
gated_mix__mha_block__softmax_full_mha__prompt_kernel_spin2_ok:
    s_add_u32 m0, s61, 98304
    s_add_u32 s29, s60, 1048576
    buffer_load_dwordx4 v240, s[4:7], s29 offen lds
    s_add_u32 m0, s61, 99328
    s_add_u32 s29, s60, 1064960
    buffer_load_dwordx4 v240, s[4:7], s29 offen lds
    s_add_u32 m0, s61, 114688
    s_add_u32 s29, s60, 1179648
    buffer_load_dwordx4 v240, s[4:7], s29 offen lds
    s_add_u32 m0, s61, 115712
    s_add_u32 s29, s60, 1196032
    buffer_load_dwordx4 v240, s[4:7], s29 offen lds
gated_mix__mha_block__softmax_full_mha__prompt_kernel_sig2:
    v_add_u32 v241, s61, v5
    v_mov_b32 v160, 0
    v_mov_b32 v161, 0
    v_mov_b32 v162, 0
    v_mov_b32 v163, 0
    v_mov_b32 v164, 0
    v_mov_b32 v165, 0
    v_mov_b32 v166, 0
    v_mov_b32 v167, 0
    v_mov_b32 v168, 0
    v_mov_b32 v169, 0
    v_mov_b32 v170, 0
    v_mov_b32 v171, 0
    v_mov_b32 v172, 0
    v_mov_b32 v173, 0
    v_mov_b32 v174, 0
    v_mov_b32 v175, 0
    v_mov_b32 v176, 0
    v_mov_b32 v177, 0
    v_mov_b32 v178, 0
    v_mov_b32 v179, 0
    v_mov_b32 v180, 0
    v_mov_b32 v181, 0
    v_mov_b32 v182, 0
    v_mov_b32 v183, 0
    v_mov_b32 v184, 0
    v_mov_b32 v185, 0
    v_mov_b32 v186, 0
    v_mov_b32 v187, 0
    v_mov_b32 v188, 0
    v_mov_b32 v189, 0
    v_mov_b32 v190, 0
    v_mov_b32 v191, 0
    s_barrier
    s_add_u32 s28, s30, 0
    buffer_load_dwordx4 v[16:19], v5, s[12:15], s28 offen offset:0 sc1
    buffer_load_dwordx4 v[20:23], v5, s[12:15], s28 offen offset:1024 sc1
    buffer_load_dwordx4 v[24:27], v5, s[12:15], s28 offen offset:2048 sc1
    buffer_load_dwordx4 v[28:31], v5, s[12:15], s28 offen offset:3072 sc1
    s_add_u32 s28, s30, 4096
    buffer_load_dwordx4 v[32:35], v5, s[12:15], s28 offen offset:0 sc1
    buffer_load_dwordx4 v[36:39], v5, s[12:15], s28 offen offset:1024 sc1
    buffer_load_dwordx4 v[40:43], v5, s[12:15], s28 offen offset:2048 sc1
    buffer_load_dwordx4 v[44:47], v5, s[12:15], s28 offen offset:3072 sc1
    s_add_u32 s28, s30, 8192
    buffer_load_dwordx4 v[48:51], v5, s[12:15], s28 offen offset:0 sc1
    buffer_load_dwordx4 v[52:55], v5, s[12:15], s28 offen offset:1024 sc1
    buffer_load_dwordx4 v[56:59], v5, s[12:15], s28 offen offset:2048 sc1
    buffer_load_dwordx4 v[60:63], v5, s[12:15], s28 offen offset:3072 sc1
    s_add_u32 s28, s30, 12288
    buffer_load_dwordx4 v[64:67], v5, s[12:15], s28 offen offset:0 sc1
    buffer_load_dwordx4 v[68:71], v5, s[12:15], s28 offen offset:1024 sc1
    buffer_load_dwordx4 v[72:75], v5, s[12:15], s28 offen offset:2048 sc1
    buffer_load_dwordx4 v[76:79], v5, s[12:15], s28 offen offset:3072 sc1
    v_lshrrev_b32 v247, 3, v0
    s_lshl_b32 s28, s62, 7
    v_add_u32 v248, s28, v247
    v_lshlrev_b32 v242, 2, v248
    v_add_u32 v242, 33554432, v242
    buffer_load_dword v243, v242, s[12:15], 0 offen sc1
    buffer_load_dword v244, v242, s[12:15], 0 offen offset:256 sc1
    v_and_b32 v2, 31, v1
    s_lshl_b32 s28, s21, 5
    v_add_u32 v2, s28, v2
    v_lshrrev_b32 v3, 5, v1
    v_and_b32 v4, 15, v2
    v_xor_b32 v3, v3, v4
    s_lshl_b32 s28, s22, 15
    s_add_u32 s28, s28, 65536
    v_lshlrev_b32 v2, 8, v2
    v_add_u32 v2, s28, v2
    v_xor_b32 v4, 0, v3
    v_lshl_add_u32 v80, v4, 4, v2
    v_xor_b32 v4, 2, v3
    v_lshl_add_u32 v81, v4, 4, v2
    v_xor_b32 v4, 4, v3
    v_lshl_add_u32 v82, v4, 4, v2
    v_xor_b32 v4, 6, v3
    v_lshl_add_u32 v83, v4, 4, v2
    v_xor_b32 v4, 8, v3
    v_lshl_add_u32 v88, v4, 4, v2
    v_xor_b32 v4, 10, v3
    v_lshl_add_u32 v89, v4, 4, v2
    v_xor_b32 v4, 12, v3
    v_lshl_add_u32 v90, v4, 4, v2
    v_xor_b32 v4, 14, v3
    v_lshl_add_u32 v91, v4, 4, v2
    v_and_b32 v2, 7, v0
    v_lshlrev_b32 v3, 1, v2
    v_and_b32 v4, 15, v247
    v_xor_b32 v3, v3, v4
    v_lshlrev_b32 v4, 8, v247
    v_add_u32 v4, 65536, v4
    v_lshl_add_u32 v92, v3, 4, v4
    v_xor_b32 v93, 16, v92
    v_lshlrev_b32 v94, 11, v248
    v_lshl_add_u32 v94, v2, 4, v94
    s_lshl_b32 s33, s46, 7
    ds_read_b64_tr_b16 v[96:97], v12 offset:0
    ds_read_b64_tr_b16 v[98:99], v12 offset:1024
    ds_read_b64_tr_b16 v[100:101], v13 offset:0
    ds_read_b64_tr_b16 v[102:103], v13 offset:1024
    ds_read_b64_tr_b16 v[104:105], v12 offset:2048
    ds_read_b64_tr_b16 v[106:107], v12 offset:3072
    ds_read_b64_tr_b16 v[108:109], v13 offset:2048
    ds_read_b64_tr_b16 v[110:111], v13 offset:3072
    s_waitcnt lgkmcnt(4)
    ds_read_b64_tr_b16 v[112:113], v12 offset:4096
    ds_read_b64_tr_b16 v[114:115], v12 offset:5120
    ds_read_b64_tr_b16 v[116:117], v13 offset:4096
    ds_read_b64_tr_b16 v[118:119], v13 offset:5120
    ds_read_b64_tr_b16 v[120:121], v12 offset:6144
    ds_read_b64_tr_b16 v[122:123], v12 offset:7168
    ds_read_b64_tr_b16 v[124:125], v13 offset:6144
    ds_read_b64_tr_b16 v[126:127], v13 offset:7168
    s_waitcnt vmcnt(14) lgkmcnt(0)
    v_mfma_f32_32x32x16_bf16 v[160:175], v[96:99], v[16:19], v[160:175]
    ds_read_b64_tr_b16 v[128:129], v12 offset:16384
    ds_read_b64_tr_b16 v[130:131], v12 offset:17408
    ds_read_b64_tr_b16 v[132:133], v13 offset:16384
    v_mfma_f32_32x32x16_bf16 v[176:191], v[100:103], v[16:19], v[176:191]
    ds_read_b64_tr_b16 v[134:135], v13 offset:17408
    ds_read_b64_tr_b16 v[136:137], v12 offset:18432
    ds_read_b64_tr_b16 v[138:139], v12 offset:19456
    v_mfma_f32_32x32x16_bf16 v[160:175], v[104:107], v[20:23], v[160:175]
    ds_read_b64_tr_b16 v[140:141], v13 offset:18432
    ds_read_b64_tr_b16 v[142:143], v13 offset:19456
    ds_read_b64_tr_b16 v[144:145], v12 offset:20480
    v_mfma_f32_32x32x16_bf16 v[176:191], v[108:111], v[20:23], v[176:191]
    ds_read_b64_tr_b16 v[146:147], v12 offset:21504
    ds_read_b64_tr_b16 v[148:149], v13 offset:20480
    ds_read_b64_tr_b16 v[150:151], v13 offset:21504
    v_mfma_f32_32x32x16_bf16 v[160:175], v[112:115], v[24:27], v[160:175]
    s_waitcnt lgkmcnt(8)
    ds_read_b64_tr_b16 v[152:153], v12 offset:22528
    ds_read_b64_tr_b16 v[154:155], v12 offset:23552
    v_mfma_f32_32x32x16_bf16 v[176:191], v[116:119], v[24:27], v[176:191]
    ds_read_b64_tr_b16 v[156:157], v13 offset:22528
    ds_read_b64_tr_b16 v[158:159], v13 offset:23552
    v_mfma_f32_32x32x16_bf16 v[160:175], v[120:123], v[28:31], v[160:175]
    v_mfma_f32_32x32x16_bf16 v[176:191], v[124:127], v[28:31], v[176:191]
    s_waitcnt vmcnt(10) lgkmcnt(0)
    v_mfma_f32_32x32x16_bf16 v[160:175], v[128:131], v[32:35], v[160:175]
    ds_read_b64_tr_b16 v[96:97], v8 offset:0
    ds_read_b64_tr_b16 v[98:99], v8 offset:1024
    ds_read_b64_tr_b16 v[100:101], v9 offset:0
    v_mfma_f32_32x32x16_bf16 v[176:191], v[132:135], v[32:35], v[176:191]
    ds_read_b64_tr_b16 v[102:103], v9 offset:1024
    ds_read_b64_tr_b16 v[104:105], v8 offset:2048
    ds_read_b64_tr_b16 v[106:107], v8 offset:3072
    s_add_u32 s28, s30, 16384
    buffer_load_dwordx4 v[16:19], v5, s[12:15], s28 offen offset:0 sc1
    buffer_load_dwordx4 v[20:23], v5, s[12:15], s28 offen offset:1024 sc1
    buffer_load_dwordx4 v[24:27], v5, s[12:15], s28 offen offset:2048 sc1
    buffer_load_dwordx4 v[28:31], v5, s[12:15], s28 offen offset:3072 sc1
    v_mfma_f32_32x32x16_bf16 v[160:175], v[136:139], v[36:39], v[160:175]
    ds_read_b64_tr_b16 v[108:109], v9 offset:2048
    ds_read_b64_tr_b16 v[110:111], v9 offset:3072
    ds_read_b64_tr_b16 v[112:113], v8 offset:4096
    v_mfma_f32_32x32x16_bf16 v[176:191], v[140:143], v[36:39], v[176:191]
    ds_read_b64_tr_b16 v[114:115], v8 offset:5120
    ds_read_b64_tr_b16 v[116:117], v9 offset:4096
    ds_read_b64_tr_b16 v[118:119], v9 offset:5120
    v_mfma_f32_32x32x16_bf16 v[160:175], v[144:147], v[40:43], v[160:175]
    s_waitcnt lgkmcnt(8)
    ds_read_b64_tr_b16 v[120:121], v8 offset:6144
    ds_read_b64_tr_b16 v[122:123], v8 offset:7168
    v_mfma_f32_32x32x16_bf16 v[176:191], v[148:151], v[40:43], v[176:191]
    ds_read_b64_tr_b16 v[124:125], v9 offset:6144
    ds_read_b64_tr_b16 v[126:127], v9 offset:7168
    v_mfma_f32_32x32x16_bf16 v[160:175], v[152:155], v[44:47], v[160:175]
    v_mfma_f32_32x32x16_bf16 v[176:191], v[156:159], v[44:47], v[176:191]
    s_waitcnt vmcnt(10) lgkmcnt(0)
    v_mfma_f32_32x32x16_bf16 v[160:175], v[96:99], v[48:51], v[160:175]
    ds_read_b64_tr_b16 v[128:129], v8 offset:16384
    ds_read_b64_tr_b16 v[130:131], v8 offset:17408
    ds_read_b64_tr_b16 v[132:133], v9 offset:16384
    v_mfma_f32_32x32x16_bf16 v[176:191], v[100:103], v[48:51], v[176:191]
    ds_read_b64_tr_b16 v[134:135], v9 offset:17408
    ds_read_b64_tr_b16 v[136:137], v8 offset:18432
    ds_read_b64_tr_b16 v[138:139], v8 offset:19456
    s_add_u32 s28, s30, 20480
    buffer_load_dwordx4 v[32:35], v5, s[12:15], s28 offen offset:0 sc1
    buffer_load_dwordx4 v[36:39], v5, s[12:15], s28 offen offset:1024 sc1
    buffer_load_dwordx4 v[40:43], v5, s[12:15], s28 offen offset:2048 sc1
    buffer_load_dwordx4 v[44:47], v5, s[12:15], s28 offen offset:3072 sc1
    v_mfma_f32_32x32x16_bf16 v[160:175], v[104:107], v[52:55], v[160:175]
    ds_read_b64_tr_b16 v[140:141], v9 offset:18432
    ds_read_b64_tr_b16 v[142:143], v9 offset:19456
    ds_read_b64_tr_b16 v[144:145], v8 offset:20480
    v_mfma_f32_32x32x16_bf16 v[176:191], v[108:111], v[52:55], v[176:191]
    ds_read_b64_tr_b16 v[146:147], v8 offset:21504
    ds_read_b64_tr_b16 v[148:149], v9 offset:20480
    ds_read_b64_tr_b16 v[150:151], v9 offset:21504
    v_mfma_f32_32x32x16_bf16 v[160:175], v[112:115], v[56:59], v[160:175]
    s_waitcnt lgkmcnt(8)
    ds_read_b64_tr_b16 v[152:153], v8 offset:22528
    ds_read_b64_tr_b16 v[154:155], v8 offset:23552
    v_mfma_f32_32x32x16_bf16 v[176:191], v[116:119], v[56:59], v[176:191]
    ds_read_b64_tr_b16 v[156:157], v9 offset:22528
    ds_read_b64_tr_b16 v[158:159], v9 offset:23552
    v_mfma_f32_32x32x16_bf16 v[160:175], v[120:123], v[60:63], v[160:175]
    v_mfma_f32_32x32x16_bf16 v[176:191], v[124:127], v[60:63], v[176:191]
    s_waitcnt vmcnt(10) lgkmcnt(0)
    v_mfma_f32_32x32x16_bf16 v[160:175], v[128:131], v[64:67], v[160:175]
    ds_read_b64_tr_b16 v[96:97], v8 offset:32768
    ds_read_b64_tr_b16 v[98:99], v8 offset:33792
    ds_read_b64_tr_b16 v[100:101], v9 offset:32768
    v_mfma_f32_32x32x16_bf16 v[176:191], v[132:135], v[64:67], v[176:191]
    ds_read_b64_tr_b16 v[102:103], v9 offset:33792
    ds_read_b64_tr_b16 v[104:105], v8 offset:34816
    ds_read_b64_tr_b16 v[106:107], v8 offset:35840
    s_add_u32 s28, s30, 24576
    buffer_load_dwordx4 v[48:51], v5, s[12:15], s28 offen offset:0 sc1
    buffer_load_dwordx4 v[52:55], v5, s[12:15], s28 offen offset:1024 sc1
    buffer_load_dwordx4 v[56:59], v5, s[12:15], s28 offen offset:2048 sc1
    buffer_load_dwordx4 v[60:63], v5, s[12:15], s28 offen offset:3072 sc1
    v_mfma_f32_32x32x16_bf16 v[160:175], v[136:139], v[68:71], v[160:175]
    ds_read_b64_tr_b16 v[108:109], v9 offset:34816
    ds_read_b64_tr_b16 v[110:111], v9 offset:35840
    ds_read_b64_tr_b16 v[112:113], v8 offset:36864
    v_mfma_f32_32x32x16_bf16 v[176:191], v[140:143], v[68:71], v[176:191]
    ds_read_b64_tr_b16 v[114:115], v8 offset:37888
    ds_read_b64_tr_b16 v[116:117], v9 offset:36864
    ds_read_b64_tr_b16 v[118:119], v9 offset:37888
    v_mfma_f32_32x32x16_bf16 v[160:175], v[144:147], v[72:75], v[160:175]
    s_waitcnt lgkmcnt(8)
    ds_read_b64_tr_b16 v[120:121], v8 offset:38912
    ds_read_b64_tr_b16 v[122:123], v8 offset:39936
    v_mfma_f32_32x32x16_bf16 v[176:191], v[148:151], v[72:75], v[176:191]
    ds_read_b64_tr_b16 v[124:125], v9 offset:38912
    ds_read_b64_tr_b16 v[126:127], v9 offset:39936
    v_mfma_f32_32x32x16_bf16 v[160:175], v[152:155], v[76:79], v[160:175]
    v_mfma_f32_32x32x16_bf16 v[176:191], v[156:159], v[76:79], v[176:191]
    s_waitcnt vmcnt(8) lgkmcnt(0)
    v_mfma_f32_32x32x16_bf16 v[160:175], v[96:99], v[16:19], v[160:175]
    ds_read_b64_tr_b16 v[128:129], v8 offset:49152
    ds_read_b64_tr_b16 v[130:131], v8 offset:50176
    ds_read_b64_tr_b16 v[132:133], v9 offset:49152
    v_mfma_f32_32x32x16_bf16 v[176:191], v[100:103], v[16:19], v[176:191]
    ds_read_b64_tr_b16 v[134:135], v9 offset:50176
    ds_read_b64_tr_b16 v[136:137], v8 offset:51200
    ds_read_b64_tr_b16 v[138:139], v8 offset:52224
    s_add_u32 s28, s30, 28672
    buffer_load_dwordx4 v[64:67], v5, s[12:15], s28 offen offset:0 sc1
    buffer_load_dwordx4 v[68:71], v5, s[12:15], s28 offen offset:1024 sc1
    buffer_load_dwordx4 v[72:75], v5, s[12:15], s28 offen offset:2048 sc1
    buffer_load_dwordx4 v[76:79], v5, s[12:15], s28 offen offset:3072 sc1
    v_mfma_f32_32x32x16_bf16 v[160:175], v[104:107], v[20:23], v[160:175]
    ds_read_b64_tr_b16 v[140:141], v9 offset:51200
    ds_read_b64_tr_b16 v[142:143], v9 offset:52224
    ds_read_b64_tr_b16 v[144:145], v8 offset:53248
    v_mfma_f32_32x32x16_bf16 v[176:191], v[108:111], v[20:23], v[176:191]
    ds_read_b64_tr_b16 v[146:147], v8 offset:54272
    ds_read_b64_tr_b16 v[148:149], v9 offset:53248
    ds_read_b64_tr_b16 v[150:151], v9 offset:54272
    v_mfma_f32_32x32x16_bf16 v[160:175], v[112:115], v[24:27], v[160:175]
    s_waitcnt lgkmcnt(8)
    ds_read_b64_tr_b16 v[152:153], v8 offset:55296
    ds_read_b64_tr_b16 v[154:155], v8 offset:56320
    v_mfma_f32_32x32x16_bf16 v[176:191], v[116:119], v[24:27], v[176:191]
    ds_read_b64_tr_b16 v[156:157], v9 offset:55296
    ds_read_b64_tr_b16 v[158:159], v9 offset:56320
    v_mfma_f32_32x32x16_bf16 v[160:175], v[120:123], v[28:31], v[160:175]
    v_mfma_f32_32x32x16_bf16 v[176:191], v[124:127], v[28:31], v[176:191]
    s_waitcnt vmcnt(8) lgkmcnt(0)
    v_mfma_f32_32x32x16_bf16 v[160:175], v[128:131], v[32:35], v[160:175]
    ds_read_b64_tr_b16 v[96:97], v10 offset:0
    ds_read_b64_tr_b16 v[98:99], v10 offset:1024
    ds_read_b64_tr_b16 v[100:101], v11 offset:0
    v_mfma_f32_32x32x16_bf16 v[176:191], v[132:135], v[32:35], v[176:191]
    ds_read_b64_tr_b16 v[102:103], v11 offset:1024
    ds_read_b64_tr_b16 v[104:105], v10 offset:2048
    ds_read_b64_tr_b16 v[106:107], v10 offset:3072
    s_add_u32 s28, s30, 32768
    buffer_load_dwordx4 v[16:19], v5, s[12:15], s28 offen offset:0 sc1
    buffer_load_dwordx4 v[20:23], v5, s[12:15], s28 offen offset:1024 sc1
    buffer_load_dwordx4 v[24:27], v5, s[12:15], s28 offen offset:2048 sc1
    buffer_load_dwordx4 v[28:31], v5, s[12:15], s28 offen offset:3072 sc1
    v_mfma_f32_32x32x16_bf16 v[160:175], v[136:139], v[36:39], v[160:175]
    ds_read_b64_tr_b16 v[108:109], v11 offset:2048
    ds_read_b64_tr_b16 v[110:111], v11 offset:3072
    ds_read_b64_tr_b16 v[112:113], v10 offset:4096
    v_mfma_f32_32x32x16_bf16 v[176:191], v[140:143], v[36:39], v[176:191]
    ds_read_b64_tr_b16 v[114:115], v10 offset:5120
    ds_read_b64_tr_b16 v[116:117], v11 offset:4096
    ds_read_b64_tr_b16 v[118:119], v11 offset:5120
    v_mfma_f32_32x32x16_bf16 v[160:175], v[144:147], v[40:43], v[160:175]
    s_waitcnt lgkmcnt(8)
    ds_read_b64_tr_b16 v[120:121], v10 offset:6144
    ds_read_b64_tr_b16 v[122:123], v10 offset:7168
    v_mfma_f32_32x32x16_bf16 v[176:191], v[148:151], v[40:43], v[176:191]
    ds_read_b64_tr_b16 v[124:125], v11 offset:6144
    ds_read_b64_tr_b16 v[126:127], v11 offset:7168
    v_mfma_f32_32x32x16_bf16 v[160:175], v[152:155], v[44:47], v[160:175]
    v_mfma_f32_32x32x16_bf16 v[176:191], v[156:159], v[44:47], v[176:191]
    s_waitcnt vmcnt(8) lgkmcnt(0)
    s_barrier
    v_mfma_f32_32x32x16_bf16 v[160:175], v[96:99], v[48:51], v[160:175]
    v_add_u32 v2, 131072, v241
    ds_write_b128 v2, v[196:199]
    v_add_u32 v2, 132096, v241
    ds_write_b128 v2, v[200:203]
    v_add_u32 v2, 147456, v241
    ds_write_b128 v2, v[204:207]
    v_add_u32 v2, 148480, v241
    ds_write_b128 v2, v[208:211]
    v_mfma_f32_32x32x16_bf16 v[176:191], v[100:103], v[48:51], v[176:191]
    ds_read_b64_tr_b16 v[128:129], v10 offset:16384
    ds_read_b64_tr_b16 v[130:131], v10 offset:17408
    ds_read_b64_tr_b16 v[132:133], v11 offset:16384
    s_add_u32 s28, s30, 36864
    buffer_load_dwordx4 v[32:35], v5, s[12:15], s28 offen offset:0 sc1
    buffer_load_dwordx4 v[36:39], v5, s[12:15], s28 offen offset:1024 sc1
    buffer_load_dwordx4 v[40:43], v5, s[12:15], s28 offen offset:2048 sc1
    buffer_load_dwordx4 v[44:47], v5, s[12:15], s28 offen offset:3072 sc1
    v_mfma_f32_32x32x16_bf16 v[160:175], v[104:107], v[52:55], v[160:175]
    ds_read_b64_tr_b16 v[134:135], v11 offset:17408
    ds_read_b64_tr_b16 v[136:137], v10 offset:18432
    ds_read_b64_tr_b16 v[138:139], v10 offset:19456
    v_mfma_f32_32x32x16_bf16 v[176:191], v[108:111], v[52:55], v[176:191]
    s_waitcnt lgkmcnt(6)
    ds_read_b64_tr_b16 v[140:141], v11 offset:18432
    ds_read_b64_tr_b16 v[142:143], v11 offset:19456
    v_mfma_f32_32x32x16_bf16 v[160:175], v[112:115], v[56:59], v[160:175]
    ds_read_b64_tr_b16 v[144:145], v10 offset:20480
    ds_read_b64_tr_b16 v[146:147], v10 offset:21504
    v_mfma_f32_32x32x16_bf16 v[176:191], v[116:119], v[56:59], v[176:191]
    s_waitcnt lgkmcnt(6)
    ds_read_b64_tr_b16 v[148:149], v11 offset:20480
    ds_read_b64_tr_b16 v[150:151], v11 offset:21504
    v_mfma_f32_32x32x16_bf16 v[160:175], v[120:123], v[60:63], v[160:175]
    ds_read_b64_tr_b16 v[152:153], v10 offset:22528
    ds_read_b64_tr_b16 v[154:155], v10 offset:23552
    v_mfma_f32_32x32x16_bf16 v[176:191], v[124:127], v[60:63], v[176:191]
    ds_read_b64_tr_b16 v[156:157], v11 offset:22528
    ds_read_b64_tr_b16 v[158:159], v11 offset:23552
    s_waitcnt vmcnt(8) lgkmcnt(0)
    v_mfma_f32_32x32x16_bf16 v[160:175], v[128:131], v[64:67], v[160:175]
    ds_write_b128 v241, v[212:215] offset:0
    ds_write_b128 v241, v[216:219] offset:1024
    ds_write_b128 v241, v[220:223] offset:16384
    ds_write_b128 v241, v[224:227] offset:17408
    v_mfma_f32_32x32x16_bf16 v[176:191], v[132:135], v[64:67], v[176:191]
    ds_read_b64_tr_b16 v[96:97], v10 offset:32768
    ds_read_b64_tr_b16 v[98:99], v10 offset:33792
    ds_read_b64_tr_b16 v[100:101], v11 offset:32768
    s_add_u32 s28, s30, 40960
    buffer_load_dwordx4 v[48:51], v5, s[12:15], s28 offen offset:0 sc1
    buffer_load_dwordx4 v[52:55], v5, s[12:15], s28 offen offset:1024 sc1
    buffer_load_dwordx4 v[56:59], v5, s[12:15], s28 offen offset:2048 sc1
    buffer_load_dwordx4 v[60:63], v5, s[12:15], s28 offen offset:3072 sc1
    v_mfma_f32_32x32x16_bf16 v[160:175], v[136:139], v[68:71], v[160:175]
    ds_read_b64_tr_b16 v[102:103], v11 offset:33792
    ds_read_b64_tr_b16 v[104:105], v10 offset:34816
    ds_read_b64_tr_b16 v[106:107], v10 offset:35840
    v_mfma_f32_32x32x16_bf16 v[176:191], v[140:143], v[68:71], v[176:191]
    s_waitcnt lgkmcnt(6)
    ds_read_b64_tr_b16 v[108:109], v11 offset:34816
    ds_read_b64_tr_b16 v[110:111], v11 offset:35840
    v_mfma_f32_32x32x16_bf16 v[160:175], v[144:147], v[72:75], v[160:175]
    ds_read_b64_tr_b16 v[112:113], v10 offset:36864
    ds_read_b64_tr_b16 v[114:115], v10 offset:37888
    v_mfma_f32_32x32x16_bf16 v[176:191], v[148:151], v[72:75], v[176:191]
    s_waitcnt lgkmcnt(6)
    ds_read_b64_tr_b16 v[116:117], v11 offset:36864
    ds_read_b64_tr_b16 v[118:119], v11 offset:37888
    v_mfma_f32_32x32x16_bf16 v[160:175], v[152:155], v[76:79], v[160:175]
    ds_read_b64_tr_b16 v[120:121], v10 offset:38912
    ds_read_b64_tr_b16 v[122:123], v10 offset:39936
    v_mfma_f32_32x32x16_bf16 v[176:191], v[156:159], v[76:79], v[176:191]
    ds_read_b64_tr_b16 v[124:125], v11 offset:38912
    ds_read_b64_tr_b16 v[126:127], v11 offset:39936
    s_waitcnt vmcnt(8) lgkmcnt(0)
    v_mfma_f32_32x32x16_bf16 v[160:175], v[96:99], v[16:19], v[160:175]
    ds_write_b128 v241, v[228:231] offset:32768
    ds_write_b128 v241, v[232:235] offset:33792
    ds_write_b128 v241, v[236:239] offset:49152
    ds_write_b128 v241, v[84:87] offset:50176
    v_mfma_f32_32x32x16_bf16 v[176:191], v[100:103], v[16:19], v[176:191]
    ds_read_b64_tr_b16 v[128:129], v10 offset:49152
    ds_read_b64_tr_b16 v[130:131], v10 offset:50176
    ds_read_b64_tr_b16 v[132:133], v11 offset:49152
    s_add_u32 s28, s30, 45056
    buffer_load_dwordx4 v[64:67], v5, s[12:15], s28 offen offset:0 sc1
    buffer_load_dwordx4 v[68:71], v5, s[12:15], s28 offen offset:1024 sc1
    buffer_load_dwordx4 v[72:75], v5, s[12:15], s28 offen offset:2048 sc1
    buffer_load_dwordx4 v[76:79], v5, s[12:15], s28 offen offset:3072 sc1
    v_mfma_f32_32x32x16_bf16 v[160:175], v[104:107], v[20:23], v[160:175]
    ds_read_b64_tr_b16 v[134:135], v11 offset:50176
    ds_read_b64_tr_b16 v[136:137], v10 offset:51200
    ds_read_b64_tr_b16 v[138:139], v10 offset:52224
    v_mfma_f32_32x32x16_bf16 v[176:191], v[108:111], v[20:23], v[176:191]
    s_waitcnt lgkmcnt(6)
    ds_read_b64_tr_b16 v[140:141], v11 offset:51200
    ds_read_b64_tr_b16 v[142:143], v11 offset:52224
    v_mfma_f32_32x32x16_bf16 v[160:175], v[112:115], v[24:27], v[160:175]
    ds_read_b64_tr_b16 v[144:145], v10 offset:53248
    ds_read_b64_tr_b16 v[146:147], v10 offset:54272
    v_mfma_f32_32x32x16_bf16 v[176:191], v[116:119], v[24:27], v[176:191]
    s_waitcnt lgkmcnt(6)
    ds_read_b64_tr_b16 v[148:149], v11 offset:53248
    ds_read_b64_tr_b16 v[150:151], v11 offset:54272
    v_mfma_f32_32x32x16_bf16 v[160:175], v[120:123], v[28:31], v[160:175]
    ds_read_b64_tr_b16 v[152:153], v10 offset:55296
    ds_read_b64_tr_b16 v[154:155], v10 offset:56320
    v_mfma_f32_32x32x16_bf16 v[176:191], v[124:127], v[28:31], v[176:191]
    ds_read_b64_tr_b16 v[156:157], v11 offset:55296
    ds_read_b64_tr_b16 v[158:159], v11 offset:56320
    s_waitcnt vmcnt(8) lgkmcnt(0)
    s_barrier
    v_mfma_f32_32x32x16_bf16 v[160:175], v[128:131], v[32:35], v[160:175]
    ds_read_b64_tr_b16 v[96:97], v12 offset:0
    ds_read_b64_tr_b16 v[98:99], v12 offset:1024
    ds_read_b64_tr_b16 v[100:101], v13 offset:0
    v_mfma_f32_32x32x16_bf16 v[176:191], v[132:135], v[32:35], v[176:191]
    ds_read_b64_tr_b16 v[102:103], v13 offset:1024
    ds_read_b64_tr_b16 v[104:105], v12 offset:2048
    ds_read_b64_tr_b16 v[106:107], v12 offset:3072
    s_add_u32 s28, s30, 49152
    buffer_load_dwordx4 v[16:19], v5, s[12:15], s28 offen offset:0 sc1
    buffer_load_dwordx4 v[20:23], v5, s[12:15], s28 offen offset:1024 sc1
    buffer_load_dwordx4 v[24:27], v5, s[12:15], s28 offen offset:2048 sc1
    buffer_load_dwordx4 v[28:31], v5, s[12:15], s28 offen offset:3072 sc1
    v_mfma_f32_32x32x16_bf16 v[160:175], v[136:139], v[36:39], v[160:175]
    ds_read_b64_tr_b16 v[108:109], v13 offset:2048
    ds_read_b64_tr_b16 v[110:111], v13 offset:3072
    ds_read_b64_tr_b16 v[112:113], v12 offset:4096
    v_mfma_f32_32x32x16_bf16 v[176:191], v[140:143], v[36:39], v[176:191]
    ds_read_b64_tr_b16 v[114:115], v12 offset:5120
    ds_read_b64_tr_b16 v[116:117], v13 offset:4096
    ds_read_b64_tr_b16 v[118:119], v13 offset:5120
    v_mfma_f32_32x32x16_bf16 v[160:175], v[144:147], v[40:43], v[160:175]
    s_waitcnt lgkmcnt(8)
    ds_read_b64_tr_b16 v[120:121], v12 offset:6144
    ds_read_b64_tr_b16 v[122:123], v12 offset:7168
    v_mfma_f32_32x32x16_bf16 v[176:191], v[148:151], v[40:43], v[176:191]
    ds_read_b64_tr_b16 v[124:125], v13 offset:6144
    ds_read_b64_tr_b16 v[126:127], v13 offset:7168
    v_mfma_f32_32x32x16_bf16 v[160:175], v[152:155], v[44:47], v[160:175]
    v_mfma_f32_32x32x16_bf16 v[176:191], v[156:159], v[44:47], v[176:191]
    s_waitcnt vmcnt(8) lgkmcnt(0)
    v_mfma_f32_32x32x16_bf16 v[160:175], v[96:99], v[48:51], v[160:175]
    ds_read_b64_tr_b16 v[128:129], v12 offset:16384
    ds_read_b64_tr_b16 v[130:131], v12 offset:17408
    ds_read_b64_tr_b16 v[132:133], v13 offset:16384
    v_mfma_f32_32x32x16_bf16 v[176:191], v[100:103], v[48:51], v[176:191]
    ds_read_b64_tr_b16 v[134:135], v13 offset:17408
    ds_read_b64_tr_b16 v[136:137], v12 offset:18432
    ds_read_b64_tr_b16 v[138:139], v12 offset:19456
    s_add_u32 s28, s30, 53248
    buffer_load_dwordx4 v[32:35], v5, s[12:15], s28 offen offset:0 sc1
    buffer_load_dwordx4 v[36:39], v5, s[12:15], s28 offen offset:1024 sc1
    buffer_load_dwordx4 v[40:43], v5, s[12:15], s28 offen offset:2048 sc1
    buffer_load_dwordx4 v[44:47], v5, s[12:15], s28 offen offset:3072 sc1
    v_mfma_f32_32x32x16_bf16 v[160:175], v[104:107], v[52:55], v[160:175]
    ds_read_b64_tr_b16 v[140:141], v13 offset:18432
    ds_read_b64_tr_b16 v[142:143], v13 offset:19456
    ds_read_b64_tr_b16 v[144:145], v12 offset:20480
    v_mfma_f32_32x32x16_bf16 v[176:191], v[108:111], v[52:55], v[176:191]
    ds_read_b64_tr_b16 v[146:147], v12 offset:21504
    ds_read_b64_tr_b16 v[148:149], v13 offset:20480
    ds_read_b64_tr_b16 v[150:151], v13 offset:21504
    v_mfma_f32_32x32x16_bf16 v[160:175], v[112:115], v[56:59], v[160:175]
    s_waitcnt lgkmcnt(8)
    ds_read_b64_tr_b16 v[152:153], v12 offset:22528
    ds_read_b64_tr_b16 v[154:155], v12 offset:23552
    v_mfma_f32_32x32x16_bf16 v[176:191], v[116:119], v[56:59], v[176:191]
    ds_read_b64_tr_b16 v[156:157], v13 offset:22528
    ds_read_b64_tr_b16 v[158:159], v13 offset:23552
    v_mfma_f32_32x32x16_bf16 v[160:175], v[120:123], v[60:63], v[160:175]
    v_mfma_f32_32x32x16_bf16 v[176:191], v[124:127], v[60:63], v[176:191]
    s_waitcnt vmcnt(8) lgkmcnt(0)
    v_mfma_f32_32x32x16_bf16 v[160:175], v[128:131], v[64:67], v[160:175]
    ds_read_b64_tr_b16 v[96:97], v8 offset:0
    ds_read_b64_tr_b16 v[98:99], v8 offset:1024
    ds_read_b64_tr_b16 v[100:101], v9 offset:0
    v_mfma_f32_32x32x16_bf16 v[176:191], v[132:135], v[64:67], v[176:191]
    ds_read_b64_tr_b16 v[102:103], v9 offset:1024
    ds_read_b64_tr_b16 v[104:105], v8 offset:2048
    ds_read_b64_tr_b16 v[106:107], v8 offset:3072
    s_add_u32 s28, s30, 57344
    buffer_load_dwordx4 v[48:51], v5, s[12:15], s28 offen offset:0 sc1
    buffer_load_dwordx4 v[52:55], v5, s[12:15], s28 offen offset:1024 sc1
    buffer_load_dwordx4 v[56:59], v5, s[12:15], s28 offen offset:2048 sc1
    buffer_load_dwordx4 v[60:63], v5, s[12:15], s28 offen offset:3072 sc1
    v_mfma_f32_32x32x16_bf16 v[160:175], v[136:139], v[68:71], v[160:175]
    ds_read_b64_tr_b16 v[108:109], v9 offset:2048
    ds_read_b64_tr_b16 v[110:111], v9 offset:3072
    ds_read_b64_tr_b16 v[112:113], v8 offset:4096
    v_mfma_f32_32x32x16_bf16 v[176:191], v[140:143], v[68:71], v[176:191]
    ds_read_b64_tr_b16 v[114:115], v8 offset:5120
    ds_read_b64_tr_b16 v[116:117], v9 offset:4096
    ds_read_b64_tr_b16 v[118:119], v9 offset:5120
    v_mfma_f32_32x32x16_bf16 v[160:175], v[144:147], v[72:75], v[160:175]
    s_waitcnt lgkmcnt(8)
    ds_read_b64_tr_b16 v[120:121], v8 offset:6144
    ds_read_b64_tr_b16 v[122:123], v8 offset:7168
    v_mfma_f32_32x32x16_bf16 v[176:191], v[148:151], v[72:75], v[176:191]
    ds_read_b64_tr_b16 v[124:125], v9 offset:6144
    ds_read_b64_tr_b16 v[126:127], v9 offset:7168
    v_mfma_f32_32x32x16_bf16 v[160:175], v[152:155], v[76:79], v[160:175]
    v_mfma_f32_32x32x16_bf16 v[176:191], v[156:159], v[76:79], v[176:191]
    s_waitcnt vmcnt(8) lgkmcnt(0)
    v_mfma_f32_32x32x16_bf16 v[160:175], v[96:99], v[16:19], v[160:175]
    ds_read_b64_tr_b16 v[128:129], v8 offset:16384
    ds_read_b64_tr_b16 v[130:131], v8 offset:17408
    ds_read_b64_tr_b16 v[132:133], v9 offset:16384
    v_mfma_f32_32x32x16_bf16 v[176:191], v[100:103], v[16:19], v[176:191]
    ds_read_b64_tr_b16 v[134:135], v9 offset:17408
    ds_read_b64_tr_b16 v[136:137], v8 offset:18432
    ds_read_b64_tr_b16 v[138:139], v8 offset:19456
    s_add_u32 s28, s30, 61440
    buffer_load_dwordx4 v[64:67], v5, s[12:15], s28 offen offset:0 sc1
    buffer_load_dwordx4 v[68:71], v5, s[12:15], s28 offen offset:1024 sc1
    buffer_load_dwordx4 v[72:75], v5, s[12:15], s28 offen offset:2048 sc1
    buffer_load_dwordx4 v[76:79], v5, s[12:15], s28 offen offset:3072 sc1
    v_mfma_f32_32x32x16_bf16 v[160:175], v[104:107], v[20:23], v[160:175]
    ds_read_b64_tr_b16 v[140:141], v9 offset:18432
    ds_read_b64_tr_b16 v[142:143], v9 offset:19456
    ds_read_b64_tr_b16 v[144:145], v8 offset:20480
    v_mfma_f32_32x32x16_bf16 v[176:191], v[108:111], v[20:23], v[176:191]
    ds_read_b64_tr_b16 v[146:147], v8 offset:21504
    ds_read_b64_tr_b16 v[148:149], v9 offset:20480
    ds_read_b64_tr_b16 v[150:151], v9 offset:21504
    v_mfma_f32_32x32x16_bf16 v[160:175], v[112:115], v[24:27], v[160:175]
    s_waitcnt lgkmcnt(8)
    ds_read_b64_tr_b16 v[152:153], v8 offset:22528
    ds_read_b64_tr_b16 v[154:155], v8 offset:23552
    v_mfma_f32_32x32x16_bf16 v[176:191], v[116:119], v[24:27], v[176:191]
    ds_read_b64_tr_b16 v[156:157], v9 offset:22528
    ds_read_b64_tr_b16 v[158:159], v9 offset:23552
    v_mfma_f32_32x32x16_bf16 v[160:175], v[120:123], v[28:31], v[160:175]
    v_mfma_f32_32x32x16_bf16 v[176:191], v[124:127], v[28:31], v[176:191]
    s_waitcnt vmcnt(8) lgkmcnt(0)
    v_mfma_f32_32x32x16_bf16 v[160:175], v[128:131], v[32:35], v[160:175]
    ds_read_b64_tr_b16 v[96:97], v8 offset:32768
    ds_read_b64_tr_b16 v[98:99], v8 offset:33792
    ds_read_b64_tr_b16 v[100:101], v9 offset:32768
    v_mfma_f32_32x32x16_bf16 v[176:191], v[132:135], v[32:35], v[176:191]
    ds_read_b64_tr_b16 v[102:103], v9 offset:33792
    ds_read_b64_tr_b16 v[104:105], v8 offset:34816
    ds_read_b64_tr_b16 v[106:107], v8 offset:35840
    v_mfma_f32_32x32x16_bf16 v[160:175], v[136:139], v[36:39], v[160:175]
    ds_read_b64_tr_b16 v[108:109], v9 offset:34816
    ds_read_b64_tr_b16 v[110:111], v9 offset:35840
    ds_read_b64_tr_b16 v[112:113], v8 offset:36864
    v_mfma_f32_32x32x16_bf16 v[176:191], v[140:143], v[36:39], v[176:191]
    ds_read_b64_tr_b16 v[114:115], v8 offset:37888
    ds_read_b64_tr_b16 v[116:117], v9 offset:36864
    ds_read_b64_tr_b16 v[118:119], v9 offset:37888
    v_mfma_f32_32x32x16_bf16 v[160:175], v[144:147], v[40:43], v[160:175]
    s_waitcnt lgkmcnt(8)
    ds_read_b64_tr_b16 v[120:121], v8 offset:38912
    ds_read_b64_tr_b16 v[122:123], v8 offset:39936
    v_mfma_f32_32x32x16_bf16 v[176:191], v[148:151], v[40:43], v[176:191]
    ds_read_b64_tr_b16 v[124:125], v9 offset:38912
    ds_read_b64_tr_b16 v[126:127], v9 offset:39936
    v_mfma_f32_32x32x16_bf16 v[160:175], v[152:155], v[44:47], v[160:175]
    v_mfma_f32_32x32x16_bf16 v[176:191], v[156:159], v[44:47], v[176:191]
    s_waitcnt vmcnt(4) lgkmcnt(0)
    v_mfma_f32_32x32x16_bf16 v[160:175], v[96:99], v[48:51], v[160:175]
    ds_read_b64_tr_b16 v[128:129], v8 offset:49152
    ds_read_b64_tr_b16 v[130:131], v8 offset:50176
    ds_read_b64_tr_b16 v[132:133], v9 offset:49152
    v_mfma_f32_32x32x16_bf16 v[176:191], v[100:103], v[48:51], v[176:191]
    ds_read_b64_tr_b16 v[134:135], v9 offset:50176
    ds_read_b64_tr_b16 v[136:137], v8 offset:51200
    ds_read_b64_tr_b16 v[138:139], v8 offset:52224
    v_mfma_f32_32x32x16_bf16 v[160:175], v[104:107], v[52:55], v[160:175]
    ds_read_b64_tr_b16 v[140:141], v9 offset:51200
    ds_read_b64_tr_b16 v[142:143], v9 offset:52224
    ds_read_b64_tr_b16 v[144:145], v8 offset:53248
    v_mfma_f32_32x32x16_bf16 v[176:191], v[108:111], v[52:55], v[176:191]
    ds_read_b64_tr_b16 v[146:147], v8 offset:54272
    ds_read_b64_tr_b16 v[148:149], v9 offset:53248
    ds_read_b64_tr_b16 v[150:151], v9 offset:54272
    v_mfma_f32_32x32x16_bf16 v[160:175], v[112:115], v[56:59], v[160:175]
    s_waitcnt lgkmcnt(8)
    ds_read_b64_tr_b16 v[152:153], v8 offset:55296
    ds_read_b64_tr_b16 v[154:155], v8 offset:56320
    v_mfma_f32_32x32x16_bf16 v[176:191], v[116:119], v[56:59], v[176:191]
    ds_read_b64_tr_b16 v[156:157], v9 offset:55296
    ds_read_b64_tr_b16 v[158:159], v9 offset:56320
    v_mfma_f32_32x32x16_bf16 v[160:175], v[120:123], v[60:63], v[160:175]
    v_mfma_f32_32x32x16_bf16 v[176:191], v[124:127], v[60:63], v[176:191]
    s_waitcnt vmcnt(0) lgkmcnt(0)
    v_mfma_f32_32x32x16_bf16 v[160:175], v[128:131], v[64:67], v[160:175]
    v_mfma_f32_32x32x16_bf16 v[176:191], v[132:135], v[64:67], v[176:191]
    v_mfma_f32_32x32x16_bf16 v[160:175], v[136:139], v[68:71], v[160:175]
    v_mfma_f32_32x32x16_bf16 v[176:191], v[140:143], v[68:71], v[176:191]
    v_mfma_f32_32x32x16_bf16 v[160:175], v[144:147], v[72:75], v[160:175]
    v_mfma_f32_32x32x16_bf16 v[176:191], v[148:151], v[72:75], v[176:191]
    v_mfma_f32_32x32x16_bf16 v[160:175], v[152:155], v[76:79], v[160:175]
    v_mfma_f32_32x32x16_bf16 v[176:191], v[156:159], v[76:79], v[176:191]
    s_nop 7
    s_nop 3
    ds_write_b128 v80, v[160:163]
    ds_write_b128 v81, v[164:167]
    ds_write_b128 v82, v[168:171]
    ds_write_b128 v83, v[172:175]
    ds_write_b128 v88, v[176:179]
    ds_write_b128 v89, v[180:183]
    ds_write_b128 v90, v[184:187]
    ds_write_b128 v91, v[188:191]
    s_waitcnt lgkmcnt(0)
    s_barrier
    ds_read_b128 v[16:19], v92 offset:0
    ds_read_b128 v[20:23], v93 offset:0
    ds_read_b128 v[24:27], v92 offset:32768
    ds_read_b128 v[28:31], v93 offset:32768
    ds_read_b128 v[32:35], v92 offset:16384
    ds_read_b128 v[36:39], v93 offset:16384
    ds_read_b128 v[40:43], v92 offset:49152
    ds_read_b128 v[44:47], v93 offset:49152
    s_waitcnt vmcnt(0) lgkmcnt(0)
    v_sub_f32 v249, 1.0, v243
    v_cvt_pk_bf16_f32 v249, v249, v249
    v_lshlrev_b32 v249, 16, v249
    v_mul_f32 v16, v16, v243
    v_mul_f32 v17, v17, v243
    v_mul_f32 v18, v18, v243
    v_mul_f32 v19, v19, v243
    v_mul_f32 v20, v20, v243
    v_mul_f32 v21, v21, v243
    v_mul_f32 v22, v22, v243
    v_mul_f32 v23, v23, v243
    v_fmac_f32 v16, v24, v249
    v_fmac_f32 v17, v25, v249
    v_fmac_f32 v18, v26, v249
    v_fmac_f32 v19, v27, v249
    v_fmac_f32 v20, v28, v249
    v_fmac_f32 v21, v29, v249
    v_fmac_f32 v22, v30, v249
    v_fmac_f32 v23, v31, v249
    v_cvt_pk_bf16_f32 v48, v16, v17
    v_cvt_pk_bf16_f32 v49, v18, v19
    v_cvt_pk_bf16_f32 v50, v20, v21
    v_cvt_pk_bf16_f32 v51, v22, v23
    s_add_u32 s28, s33, 0
    buffer_store_dwordx4 v[48:51], v94, s[8:11], s28 offen sc1
    v_sub_f32 v249, 1.0, v244
    v_cvt_pk_bf16_f32 v249, v249, v249
    v_lshlrev_b32 v249, 16, v249
    v_mul_f32 v32, v32, v244
    v_mul_f32 v33, v33, v244
    v_mul_f32 v34, v34, v244
    v_mul_f32 v35, v35, v244
    v_mul_f32 v36, v36, v244
    v_mul_f32 v37, v37, v244
    v_mul_f32 v38, v38, v244
    v_mul_f32 v39, v39, v244
    v_fmac_f32 v32, v40, v249
    v_fmac_f32 v33, v41, v249
    v_fmac_f32 v34, v42, v249
    v_fmac_f32 v35, v43, v249
    v_fmac_f32 v36, v44, v249
    v_fmac_f32 v37, v45, v249
    v_fmac_f32 v38, v46, v249
    v_fmac_f32 v39, v47, v249
    v_cvt_pk_bf16_f32 v52, v32, v33
    v_cvt_pk_bf16_f32 v53, v34, v35
    v_cvt_pk_bf16_f32 v54, v36, v37
    v_cvt_pk_bf16_f32 v55, v38, v39
    s_add_u32 s28, s33, 131072
    buffer_store_dwordx4 v[52:55], v94, s[8:11], s28 offen sc1
gated_mix__mha_block__softmax_full_mha__prompt_kernel_end:
    s_endpgm
gated_mix__mha_block__softmax_full_mha__prompt_kernel_fallback:
    s_waitcnt vmcnt(0)
    v_mov_b32 v160, 0xff800000
    v_mov_b32 v161, 0xff800000
    v_mov_b32 v162, 0xff800000
    v_mov_b32 v163, 0xff800000
    v_mov_b32 v164, 0xff800000
    v_mov_b32 v165, 0xff800000
    v_mov_b32 v166, 0xff800000
    v_mov_b32 v167, 0xff800000
    v_mov_b32 v168, 0xff800000
    v_mov_b32 v169, 0xff800000
    v_mov_b32 v170, 0xff800000
    v_mov_b32 v171, 0xff800000
    v_mov_b32 v172, 0xff800000
    v_mov_b32 v173, 0xff800000
    v_mov_b32 v174, 0xff800000
    v_mov_b32 v175, 0xff800000
    v_mov_b32 v176, 0xff800000
    v_mov_b32 v177, 0xff800000
    v_mov_b32 v178, 0xff800000
    v_mov_b32 v179, 0xff800000
    v_mov_b32 v180, 0xff800000
    v_mov_b32 v181, 0xff800000
    v_mov_b32 v182, 0xff800000
    v_mov_b32 v183, 0xff800000
    v_mov_b32 v184, 0xff800000
    v_mov_b32 v185, 0xff800000
    v_mov_b32 v186, 0xff800000
    v_mov_b32 v187, 0xff800000
    v_mov_b32 v188, 0xff800000
    v_mov_b32 v189, 0xff800000
    v_mov_b32 v190, 0xff800000
    v_mov_b32 v191, 0xff800000
    s_lshl_b32 s28, s21, 11
    s_sub_u32 s33, s96, s28
    s_mov_b32 s32, 0
gated_mix__mha_block__softmax_full_mha__prompt_kernel_fb_max:
    buffer_load_dwordx4 v[24:27], v5, s[12:15], s33 offen offset:0 sc1
    buffer_load_dwordx4 v[28:31], v5, s[12:15], s33 offen offset:1024 sc1
    s_waitcnt vmcnt(0)
    v_mfma_f32_32x32x16_bf16 v[96:111], v[24:27], v[8:11], 0
    v_mfma_f32_32x32x16_bf16 v[96:111], v[28:31], v[12:15], v[96:111]
    v_mfma_f32_32x32x16_bf16 v[112:127], v[24:27], v[16:19], 0
    v_mfma_f32_32x32x16_bf16 v[112:127], v[28:31], v[20:23], v[112:127]
    s_nop 7
    s_nop 3
    v_max_f32 v160, v160, v96
    v_max_f32 v161, v161, v97
    v_max_f32 v162, v162, v98
    v_max_f32 v163, v163, v99
    v_max_f32 v164, v164, v100
    v_max_f32 v165, v165, v101
    v_max_f32 v166, v166, v102
    v_max_f32 v167, v167, v103
    v_max_f32 v168, v168, v104
    v_max_f32 v169, v169, v105
    v_max_f32 v170, v170, v106
    v_max_f32 v171, v171, v107
    v_max_f32 v172, v172, v108
    v_max_f32 v173, v173, v109
    v_max_f32 v174, v174, v110
    v_max_f32 v175, v175, v111
    v_max_f32 v176, v176, v112
    v_max_f32 v177, v177, v113
    v_max_f32 v178, v178, v114
    v_max_f32 v179, v179, v115
    v_max_f32 v180, v180, v116
    v_max_f32 v181, v181, v117
    v_max_f32 v182, v182, v118
    v_max_f32 v183, v183, v119
    v_max_f32 v184, v184, v120
    v_max_f32 v185, v185, v121
    v_max_f32 v186, v186, v122
    v_max_f32 v187, v187, v123
    v_max_f32 v188, v188, v124
    v_max_f32 v189, v189, v125
    v_max_f32 v190, v190, v126
    v_max_f32 v191, v191, v127
    s_add_u32 s33, s33, 4096
    s_add_u32 s32, s32, 1
    s_cmp_lt_u32 s32, 64
    s_cbranch_scc1 gated_mix__mha_block__softmax_full_mha__prompt_kernel_fb_max
    v_max3_f32 v192, v160, v161, v162
    v_max3_f32 v192, v192, v163, v164
    v_max3_f32 v192, v192, v165, v166
    v_max3_f32 v192, v192, v167, v168
    v_max3_f32 v192, v192, v169, v170
    v_max3_f32 v192, v192, v171, v172
    v_max3_f32 v192, v192, v173, v174
    v_max_f32 v192, v192, v175
    v_mov_b32 v193, v192
    s_nop 1
    v_permlane32_swap_b32 v192, v193
    s_nop 0
    v_max_f32 v192, v192, v193
    v_sub_f32 v160, 0, v192
    v_sub_f32 v161, 0, v192
    v_sub_f32 v162, 0, v192
    v_sub_f32 v163, 0, v192
    v_sub_f32 v164, 0, v192
    v_sub_f32 v165, 0, v192
    v_sub_f32 v166, 0, v192
    v_sub_f32 v167, 0, v192
    v_sub_f32 v168, 0, v192
    v_sub_f32 v169, 0, v192
    v_sub_f32 v170, 0, v192
    v_sub_f32 v171, 0, v192
    v_sub_f32 v172, 0, v192
    v_sub_f32 v173, 0, v192
    v_sub_f32 v174, 0, v192
    v_sub_f32 v175, 0, v192
    v_max3_f32 v192, v176, v177, v178
    v_max3_f32 v192, v192, v179, v180
    v_max3_f32 v192, v192, v181, v182
    v_max3_f32 v192, v192, v183, v184
    v_max3_f32 v192, v192, v185, v186
    v_max3_f32 v192, v192, v187, v188
    v_max3_f32 v192, v192, v189, v190
    v_max_f32 v192, v192, v191
    v_mov_b32 v193, v192
    s_nop 1
    v_permlane32_swap_b32 v192, v193
    s_nop 0
    v_max_f32 v192, v192, v193
    v_sub_f32 v176, 0, v192
    v_sub_f32 v177, 0, v192
    v_sub_f32 v178, 0, v192
    v_sub_f32 v179, 0, v192
    v_sub_f32 v180, 0, v192
    v_sub_f32 v181, 0, v192
    v_sub_f32 v182, 0, v192
    v_sub_f32 v183, 0, v192
    v_sub_f32 v184, 0, v192
    v_sub_f32 v185, 0, v192
    v_sub_f32 v186, 0, v192
    v_sub_f32 v187, 0, v192
    v_sub_f32 v188, 0, v192
    v_sub_f32 v189, 0, v192
    v_sub_f32 v190, 0, v192
    v_sub_f32 v191, 0, v192
    v_mov_b32 v128, 0
    v_mov_b32 v129, 0
    v_mov_b32 v130, 0
    v_mov_b32 v131, 0
    v_mov_b32 v132, 0
    v_mov_b32 v133, 0
    v_mov_b32 v134, 0
    v_mov_b32 v135, 0
    v_mov_b32 v136, 0
    v_mov_b32 v137, 0
    v_mov_b32 v138, 0
    v_mov_b32 v139, 0
    v_mov_b32 v140, 0
    v_mov_b32 v141, 0
    v_mov_b32 v142, 0
    v_mov_b32 v143, 0
    v_mov_b32 v72, 0
    v_mov_b32 v73, 0
    v_mov_b32 v74, 0
    v_mov_b32 v75, 0
    v_mov_b32 v144, 0
    v_mov_b32 v145, 0
    v_mov_b32 v146, 0
    v_mov_b32 v147, 0
    v_mov_b32 v148, 0
    v_mov_b32 v149, 0
    v_mov_b32 v150, 0
    v_mov_b32 v151, 0
    v_mov_b32 v152, 0
    v_mov_b32 v153, 0
    v_mov_b32 v154, 0
    v_mov_b32 v155, 0
    v_mov_b32 v156, 0
    v_mov_b32 v157, 0
    v_mov_b32 v158, 0
    v_mov_b32 v159, 0
    v_mov_b32 v76, 0
    v_mov_b32 v77, 0
    v_mov_b32 v78, 0
    v_mov_b32 v79, 0
    s_sub_u32 s33, s33, 262144
    s_mov_b32 s32, 0
gated_mix__mha_block__softmax_full_mha__prompt_kernel_fb_pv:
    buffer_load_dwordx4 v[24:27], v5, s[12:15], s33 offen offset:0 sc1
    buffer_load_dwordx4 v[40:43], v5, s[12:15], s33 offen offset:2048 sc1
    buffer_load_dwordx4 v[28:31], v5, s[12:15], s33 offen offset:1024 sc1
    buffer_load_dwordx4 v[44:47], v5, s[12:15], s33 offen offset:3072 sc1
    s_waitcnt vmcnt(0)
    v_mfma_f32_32x32x16_bf16 v[96:111], v[24:27], v[8:11], v[160:175]
    v_mfma_f32_32x32x16_bf16 v[96:111], v[28:31], v[12:15], v[96:111]
    v_mfma_f32_32x32x16_bf16 v[112:127], v[24:27], v[16:19], v[176:191]
    v_mfma_f32_32x32x16_bf16 v[112:127], v[28:31], v[20:23], v[112:127]
    s_nop 7
    s_nop 3
    v_exp_f32 v96, v96
    v_exp_f32 v97, v97
    v_exp_f32 v98, v98
    v_exp_f32 v99, v99
    v_exp_f32 v100, v100
    v_exp_f32 v101, v101
    v_exp_f32 v102, v102
    v_exp_f32 v103, v103
    v_exp_f32 v104, v104
    v_exp_f32 v105, v105
    v_exp_f32 v106, v106
    v_exp_f32 v107, v107
    v_exp_f32 v108, v108
    v_exp_f32 v109, v109
    v_exp_f32 v110, v110
    v_exp_f32 v111, v111
    v_exp_f32 v112, v112
    v_exp_f32 v113, v113
    v_exp_f32 v114, v114
    v_exp_f32 v115, v115
    v_exp_f32 v116, v116
    v_exp_f32 v117, v117
    v_exp_f32 v118, v118
    v_exp_f32 v119, v119
    v_exp_f32 v120, v120
    v_exp_f32 v121, v121
    v_exp_f32 v122, v122
    v_exp_f32 v123, v123
    v_exp_f32 v124, v124
    v_exp_f32 v125, v125
    v_exp_f32 v126, v126
    v_exp_f32 v127, v127
    s_nop 0
    v_cvt_pk_bf16_f32 v56, v96, v97
    v_cvt_pk_bf16_f32 v57, v98, v99
    v_cvt_pk_bf16_f32 v58, v100, v101
    v_cvt_pk_bf16_f32 v59, v102, v103
    v_cvt_pk_bf16_f32 v60, v104, v105
    v_cvt_pk_bf16_f32 v61, v106, v107
    v_cvt_pk_bf16_f32 v62, v108, v109
    v_cvt_pk_bf16_f32 v63, v110, v111
    v_cvt_pk_bf16_f32 v64, v112, v113
    v_cvt_pk_bf16_f32 v65, v114, v115
    v_cvt_pk_bf16_f32 v66, v116, v117
    v_cvt_pk_bf16_f32 v67, v118, v119
    v_cvt_pk_bf16_f32 v68, v120, v121
    v_cvt_pk_bf16_f32 v69, v122, v123
    v_cvt_pk_bf16_f32 v70, v124, v125
    v_cvt_pk_bf16_f32 v71, v126, v127
    s_nop 1
    v_mfma_f32_32x32x16_bf16 v[128:143], v[40:43], v[56:59], v[128:143]
    v_mfma_f32_32x32x16_bf16 v[128:143], v[44:47], v[60:63], v[128:143]
    v_smfmac_f32_16x16x64_bf16 v[72:75], v[252:255], v[56:63], v250
    v_mfma_f32_32x32x16_bf16 v[144:159], v[40:43], v[64:67], v[144:159]
    v_mfma_f32_32x32x16_bf16 v[144:159], v[44:47], v[68:71], v[144:159]
    v_smfmac_f32_16x16x64_bf16 v[76:79], v[252:255], v[64:71], v250
    s_add_u32 s33, s33, 4096
    s_add_u32 s32, s32, 1
    s_cmp_lt_u32 s32, 64
    s_cbranch_scc1 gated_mix__mha_block__softmax_full_mha__prompt_kernel_fb_pv
    s_nop 7
    s_nop 7
    v_add_f32 v72, v72, v73
    v_add_f32 v76, v76, v77
    v_rcp_f32 v192, v72
    v_rcp_f32 v194, v76
    s_nop 0
    v_mov_b32 v193, v192
    v_mov_b32 v195, v194
    v_pk_mul_f32 v[128:129], v[128:129], v[192:193]
    v_pk_mul_f32 v[130:131], v[130:131], v[192:193]
    v_pk_mul_f32 v[132:133], v[132:133], v[192:193]
    v_pk_mul_f32 v[134:135], v[134:135], v[192:193]
    v_pk_mul_f32 v[136:137], v[136:137], v[192:193]
    v_pk_mul_f32 v[138:139], v[138:139], v[192:193]
    v_pk_mul_f32 v[140:141], v[140:141], v[192:193]
    v_pk_mul_f32 v[142:143], v[142:143], v[192:193]
    v_pk_mul_f32 v[144:145], v[144:145], v[194:195]
    v_pk_mul_f32 v[146:147], v[146:147], v[194:195]
    v_pk_mul_f32 v[148:149], v[148:149], v[194:195]
    v_pk_mul_f32 v[150:151], v[150:151], v[194:195]
    v_pk_mul_f32 v[152:153], v[152:153], v[194:195]
    v_pk_mul_f32 v[154:155], v[154:155], v[194:195]
    v_pk_mul_f32 v[156:157], v[156:157], v[194:195]
    v_pk_mul_f32 v[158:159], v[158:159], v[194:195]
gated_mix__mha_block__softmax_full_mha__prompt_kernel_last:
    s_branch gated_mix__mha_block__softmax_full_mha__prompt_kernel_store_o
.section .rodata,"a"
.p2align 6
.amdhsa_kernel gated_mix__mha_block__softmax_full_mha__prompt_kernel
  .amdhsa_next_free_vgpr 256
  .amdhsa_next_free_sgpr 102
  .amdhsa_accum_offset 256
  .amdhsa_group_segment_fixed_size 0
  .amdhsa_kernarg_size 80
  .amdhsa_user_sgpr_count 2
  .amdhsa_user_sgpr_kernarg_segment_ptr 1
  .amdhsa_system_sgpr_workgroup_id_x 1
.end_amdhsa_kernel
```
